```python
import torch

def _softmax(x, axis=-1):
    return torch.softmax(x, dim=axis)
def _gelu(x):
    return torch.nn.functional.gelu(x, approximate="tanh")
def _silu(x):
    return torch.nn.functional.silu(x)
def _sigmoid(x):
    return torch.sigmoid(x)
def _layernorm(x, axis=-1, eps=1e-5):
    m = x.mean(dim=axis, keepdim=True)
    v = x.var(dim=axis, keepdim=True, unbiased=False)
    return (x - m) / torch.sqrt(v + eps)
def _scatter_add(tgt, idx, src, axis=0):
    return tgt.clone().index_add_(axis, idx, src)
def _segment_sum(src, seg, n):
    out = torch.zeros((n,) + src.shape[1:], dtype=src.dtype)
    return out.index_add_(0, seg, src)
def _pad(x, pw):
    flat = tuple(v for pair in reversed(pw) for v in pair)
    return torch.nn.functional.pad(x, flat)

kernel_name = 'sequential_preLN__sliding_block_cached__dense_activation_relu__decode'

def setup_inputs():

    _w = (lambda a: (lambda t: t.to(torch.bfloat16) if t.is_floating_point() else t)(torch.as_tensor(a)))
    def _A_setup():
        B, Sq, D = 8, 1, 1024
        Hq, Hkv, Sk, Dh = 32, 4, 4096, 128
        assert Hq % Hkv == 0, (Hq, Hkv)
        return {
            "x": _w((lambda *s: torch.randn(*s, dtype=torch.bfloat16) * 0.05)(B, Sq, D)),
            "k_cache": _w((lambda *s: torch.randn(*s, dtype=torch.bfloat16) * 3.2)(B, Hkv, Sk, Dh)),
            "v_cache": _w((lambda *s: torch.randn(*s, dtype=torch.bfloat16) * 0.4)(B, Hkv, Sk, Dh)),
            "wq": _w((lambda *s: torch.randn(*s, dtype=torch.bfloat16) * 3.2)(D, Hq * Dh) * (D ** -0.5)),
            "wo": _w((lambda *s: torch.randn(*s, dtype=torch.bfloat16) * 0.4)(Hq * Dh, D) * ((Hq * Dh) ** -0.5)),
        }
    _A_in = _A_setup()

    def _B_setup():
        B, S, D, Dff = 8, 1, 1024, 3584
        return {
            "x": _w((lambda *s: torch.randn(*s, dtype=torch.bfloat16) * 0.05)(B, S, D)),
            "w1": _w((lambda *s: torch.randn(*s, dtype=torch.bfloat16) * 0.05)(D, Dff)),
            "w2": _w((lambda *s: torch.randn(*s, dtype=torch.bfloat16) * 0.05)(Dff, D)),
        }
    _B_in = _B_setup()

    return {
        "A_x": _A_in["x"],
        "A_k_cache": _A_in["k_cache"],
        "A_v_cache": _A_in["v_cache"],
        "A_wq": _A_in["wq"],
        "A_wo": _A_in["wo"],
        "B_x": _B_in["x"],
        "B_w1": _B_in["w1"],
        "B_w2": _B_in["w2"],
    }

def reference(A_x, A_k_cache, A_v_cache, A_wq, A_wo, B_x, B_w1, B_w2):
    def _A_ref(x, k_cache, v_cache, wq, wo):
        B, Sq, D = x.shape
        Hq, Dh = 32, 128
        Hkv, Sk = k_cache.shape[1], k_cache.shape[2]
        W = min(4096, max(256, Sk // 4))
        rep = Hq // Hkv
        q = (lambda x, *d: x.permute(*d))((x @ wq).reshape(B, Sq, Hq, Dh), 0, 2, 1, 3)
        k = (lambda x, n, axis: torch.repeat_interleave(x, n, dim=axis))(k_cache[:, :, Sk - W:, :], rep, axis=1)
        v = (lambda x, n, axis: torch.repeat_interleave(x, n, dim=axis))(v_cache[:, :, Sk - W:, :], rep, axis=1)
        scores = torch.einsum("bhqd,bhkd->bhqk", q, k) * (Dh ** -0.5)
        p = _softmax(scores, axis=-1)
        o = torch.einsum("bhqk,bhkd->bhqd", p, v)
        return (lambda x, *d: x.permute(*d))(o, 0, 2, 1, 3).reshape(B, Sq, Hq * Dh) @ wo

    def _B_ref(x, w1, w2):
        h = torch.einsum("bsd,df->bsf", x, w1)
        zero = torch.zeros_like(h)
        h = torch.maximum(h, zero)
        return torch.einsum("bsf,fd->bsd", h, w2)

    x = A_x
    h = x + _A_ref(_layernorm(x, axis=-1), A_k_cache, A_v_cache, A_wq, A_wo)
    h2 = h + _B_ref(_layernorm(h, axis=-1), B_w1, B_w2)
    return h2
```

```asm
; @launch grid=(256,1,1) block=(512,1,1) lds=97408
.amdgcn_target "amdgcn-amd-amdhsa--gfx950"
.text
.globl sequential_preLN__sliding_block_cached__dense_activation_relu__decode_kernel
.p2align 8
.type sequential_preLN__sliding_block_cached__dense_activation_relu__decode_kernel,@function
sequential_preLN__sliding_block_cached__dense_activation_relu__decode_kernel:
    s_cmp_ge_u32 s2, 256
    s_cbranch_scc1 L_end
    s_load_dwordx16 s[4:19], s[0:1], 0
    s_load_dwordx4 s[20:23], s[0:1], 64
    s_load_dwordx2 s[24:25], s[0:1], 80
    v_lshrrev_b32 v7, 6, v0
    v_and_b32 v1, 63, v0
    v_and_b32 v2, 15, v0
    v_readfirstlane_b32 s3, v7
    v_lshrrev_b32 v3, 4, v1
    v_mov_b32 v4, 0
    v_mov_b32 v5, 1
    v_mov_b32 v6, 0xff
    s_and_b32 s52, s2, 7
    s_lshr_b32 s53, s2, 3
    s_mov_b32 s54, 0x05040100
    s_mov_b32 s55, 0x07060302
    v_and_b32 v0, 0xff, v0
    s_cmp_ge_u32 s3, 4
    s_cbranch_scc1 L_A
L_B:
    s_setprio 3
    s_and_b32 s3, s3, 3
    v_lshrrev_b32 v7, 5, v1
    v_and_b32 v8, 31, v1
    v_lshlrev_b32 v17, 4, v8
    v_lshl_or_b32 v17, v7, 11, v17
    s_lshl_b32 s68, s3, 12
    s_lshr_b32 s60, s2, 6
    s_and_b32 s61, s2, 63
    s_lshl_b32 s62, s60, 9
    s_add_u32 s69, s68, s62
    v_lshrrev_b32 v9, 3, v2
    v_lshlrev_b32 v9, 18, v9
    v_lshl_or_b32 v9, v3, 16, v9
    v_and_b32 v10, 7, v2
    v_lshl_or_b32 v18, v10, 4, v9
    s_lshl_b32 s62, s60, 21
    s_lshl_b32 s63, s3, 19
    s_add_u32 s62, s62, s63
    s_lshl_b32 s63, s61, 7
    s_add_u32 s62, s62, s63
    s_waitcnt lgkmcnt(0)
    s_load_dword s58, s[24:25], 0

    s_mov_b32 s40, s4
    s_mov_b32 s41, s5
    s_mov_b32 s42, 0x4000
    s_mov_b32 s43, 0x20000
    s_mov_b32 s36, s10
    s_mov_b32 s37, s11
    s_mov_b32 s38, 0x800000
    s_mov_b32 s39, 0x20000
    buffer_load_dwordx4 v[20:23], v17, s[40:43], s68 offen offset:0
    buffer_load_dwordx4 v[24:27], v17, s[40:43], s68 offen offset:512
    buffer_load_dwordx4 v[28:31], v17, s[40:43], s68 offen offset:1024
    buffer_load_dwordx4 v[32:35], v17, s[40:43], s68 offen offset:1536
    buffer_load_dwordx4 v[36:39], v17, s[40:43], s69 offen
    buffer_load_dwordx4 v[40:43], v18, s[36:39], s62 offen nt
    s_add_u32 s62, s62, 0x2000
    buffer_load_dwordx4 v[44:47], v18, s[36:39], s62 offen nt
    s_add_u32 s62, s62, 0x2000
    buffer_load_dwordx4 v[48:51], v18, s[36:39], s62 offen nt
    s_add_u32 s62, s62, 0x2000
    buffer_load_dwordx4 v[52:55], v18, s[36:39], s62 offen nt
    s_add_u32 s62, s62, 0x2000
    buffer_load_dwordx4 v[56:59], v18, s[36:39], s62 offen nt
    s_add_u32 s62, s62, 0x2000
    buffer_load_dwordx4 v[60:63], v18, s[36:39], s62 offen nt
    s_add_u32 s62, s62, 0x2000
    buffer_load_dwordx4 v[64:67], v18, s[36:39], s62 offen nt
    s_add_u32 s62, s62, 0x2000
    buffer_load_dwordx4 v[68:71], v18, s[36:39], s62 offen nt
    s_barrier
    s_mov_b32 s28, s24
    s_mov_b32 s29, s25
    s_mov_b32 s30, 0x10000000
    s_mov_b32 s31, 0x20000
    s_sub_u32 s63, s53, 16
    s_lshl_b32 s64, s63, 1
    s_and_b32 s65, s3, 1
    s_add_u32 s64, s64, s65
    s_lshl_b32 s64, s64, 3
    s_add_u32 s64, s64, s52
    s_mul_i32 s64, s64, 2176
    s_lshr_b32 s65, s3, 1
    s_lshl_b32 s65, s65, 10
    s_add_u32 s64, s64, s65
    s_add_u32 s64, s64, 2621440
    s_cmp_lt_u32 s63, 14
    s_cselect_b32 s64, s64, 0x10000000
    v_mov_b32 v136, -1
    v_mov_b32 v137, -1
    v_mov_b32 v138, -1
    v_mov_b32 v139, -1
    v_lshlrev_b32 v11, 4, v1
    buffer_store_dwordx4 v[136:139], v11, s[28:31], s64 offen sc1
    s_mul_i32 s62, s60, 196608
    s_mul_i32 s63, s3, 49152
    s_add_u32 s62, s62, s63
    s_mul_i32 s63, s61, 384
    s_add_u32 s62, s62, s63
    s_add_u32 s70, s62, 4194304
    s_mov_b32 s59, 0x3f803f80
    v_mov_b32 v232, 0x05040c00
    v_mov_b32 v233, 0x07060c01
    v_mov_b32 v234, 0x05040c02
    v_mov_b32 v235, 0x07060c03
    s_mul_i32 s63, s3, 1056
    v_mul_u32_u24 v17, 528, v7
    v_lshl_add_u32 v17, v8, 4, v17
    v_add_u32 v17, s63, v17
    v_mul_u32_u24 v18, 528, v10
    v_lshrrev_b32 v13, 3, v2
    v_lshl_add_u32 v18, v13, 6, v18
    v_lshl_add_u32 v18, v3, 4, v18
    s_lshl_b32 s63, s3, 7
    v_add_u32 v18, s63, v18
    s_mul_i32 s63, s3, 4352
    v_mul_u32_u24 v9, 2176, v13
    v_mul_u32_u24 v14, 272, v10
    v_add3_u32 v9, v9, v14, s63
    v_and_b32 v14, 1, v3
    v_lshl_add_u32 v9, v14, 4, v9
    s_mul_i32 s63, s3, 544
    v_mul_u32_u24 v8, 8704, v7
    v_mul_u32_u24 v13, 272, v14
    v_add3_u32 v8, v8, v13, s63
    v_lshl_add_u32 v8, v2, 4, v8
    v_mul_u32_u24 v13, 24576, v14
    v_mul_u32_u24 v14, 43, v2
    v_lshrrev_b32 v14, 7, v14
    v_add_u32 v14, 16, v14
    v_cmp_gt_u32 vcc, 32, v1
    s_nop 1
    v_cndmask_b32 v14, v14, v2, vcc
    v_lshl_add_u32 v13, v14, 4, v13
    v_mov_b32 v11, 0
    v_mov_b32 v12, 0

    s_waitcnt vmcnt(13)
    s_mov_b64 exec, 1
    ds_add_u32 v4, v5 offset:16
    s_mov_b64 exec, -1
    v_dot2_f32_bf16 v11, v20, s59, v11
    v_dot2_f32_bf16 v12, v20, v20, v12
    v_dot2_f32_bf16 v11, v21, s59, v11
    v_dot2_f32_bf16 v12, v21, v21, v12
    v_dot2_f32_bf16 v11, v22, s59, v11
    v_dot2_f32_bf16 v12, v22, v22, v12
    v_dot2_f32_bf16 v11, v23, s59, v11
    v_dot2_f32_bf16 v12, v23, v23, v12
    s_waitcnt vmcnt(12)
    v_dot2_f32_bf16 v11, v24, s59, v11
    v_dot2_f32_bf16 v12, v24, v24, v12
    v_dot2_f32_bf16 v11, v25, s59, v11
    v_dot2_f32_bf16 v12, v25, v25, v12
    v_dot2_f32_bf16 v11, v26, s59, v11
    v_dot2_f32_bf16 v12, v26, v26, v12
    v_dot2_f32_bf16 v11, v27, s59, v11
    v_dot2_f32_bf16 v12, v27, v27, v12
    s_waitcnt vmcnt(11)
    v_dot2_f32_bf16 v11, v28, s59, v11
    v_dot2_f32_bf16 v12, v28, v28, v12
    v_dot2_f32_bf16 v11, v29, s59, v11
    v_dot2_f32_bf16 v12, v29, v29, v12
    v_dot2_f32_bf16 v11, v30, s59, v11
    v_dot2_f32_bf16 v12, v30, v30, v12
    v_dot2_f32_bf16 v11, v31, s59, v11
    v_dot2_f32_bf16 v12, v31, v31, v12
    s_waitcnt vmcnt(10)
    v_dot2_f32_bf16 v11, v32, s59, v11
    v_dot2_f32_bf16 v12, v32, v32, v12
    v_dot2_f32_bf16 v11, v33, s59, v11
    v_dot2_f32_bf16 v12, v33, v33, v12
    v_dot2_f32_bf16 v11, v34, s59, v11
    v_dot2_f32_bf16 v12, v34, v34, v12
    v_dot2_f32_bf16 v11, v35, s59, v11
    v_dot2_f32_bf16 v12, v35, v35, v12
    s_nop 1
    s_nop 0
    v_add_f32_dpp v11, v11, v11 quad_perm:[1,0,3,2] row_mask:0xf bank_mask:0xf
    v_add_f32_dpp v12, v12, v12 quad_perm:[1,0,3,2] row_mask:0xf bank_mask:0xf
    s_nop 0
    v_add_f32_dpp v11, v11, v11 quad_perm:[2,3,0,1] row_mask:0xf bank_mask:0xf
    v_add_f32_dpp v12, v12, v12 quad_perm:[2,3,0,1] row_mask:0xf bank_mask:0xf
    s_nop 0
    v_add_f32_dpp v11, v11, v11 row_half_mirror row_mask:0xf bank_mask:0xf
    v_add_f32_dpp v12, v12, v12 row_half_mirror row_mask:0xf bank_mask:0xf
    s_nop 0
    v_add_f32_dpp v11, v11, v11 row_mirror row_mask:0xf bank_mask:0xf
    v_add_f32_dpp v12, v12, v12 row_mirror row_mask:0xf bank_mask:0xf
    v_mov_b32 v20, v11
    v_mov_b32 v21, v12
    s_nop 0
    v_permlane16_swap_b32 v11, v20
    v_permlane16_swap_b32 v12, v21
    v_add_f32 v11, v11, v20
    v_add_f32 v12, v12, v21
    v_mul_f32 v20, 0x3a800000, v11
    v_mul_f32 v23, 0x3a800000, v12
    v_fma_f32 v23, -v20, v20, v23
    v_max_f32 v23, 0, v23
    v_cvt_pk_bf16_f32 v20, v20, v23
    v_and_b32 v23, 0xffff0000, v20
    v_lshlrev_b32 v20, 16, v20
    v_add_f32 v23, 0x3727c5ac, v23
    v_cvt_pk_bf16_f32 v23, v23, v23
    v_and_b32 v23, 0xffff0000, v23
    v_sqrt_f32 v22, v23
    s_nop 0
    v_cvt_pk_bf16_f32 v22, v22, v22
    v_and_b32 v22, 0xffff0000, v22
    v_rcp_f32 v21, v22
    s_nop 0
    v_fma_f32 v23, -v22, v21, 1.0
    v_fma_f32 v21, v23, v21, v21
    s_waitcnt vmcnt(9)
    v_lshlrev_b32 v24, 16, v36
    v_and_b32 v25, 0xffff0000, v36
    v_lshlrev_b32 v26, 16, v37
    v_and_b32 v27, 0xffff0000, v37
    v_lshlrev_b32 v28, 16, v38
    v_and_b32 v29, 0xffff0000, v38
    v_lshlrev_b32 v30, 16, v39
    v_and_b32 v31, 0xffff0000, v39
    v_sub_f32 v24, v24, v20
    v_sub_f32 v25, v25, v20
    v_sub_f32 v26, v26, v20
    v_sub_f32 v27, v27, v20
    v_sub_f32 v28, v28, v20
    v_sub_f32 v29, v29, v20
    v_sub_f32 v30, v30, v20
    v_sub_f32 v31, v31, v20
    v_cvt_pk_bf16_f32 v36, v24, v25
    v_cvt_pk_bf16_f32 v37, v26, v27
    v_cvt_pk_bf16_f32 v38, v28, v29
    v_cvt_pk_bf16_f32 v39, v30, v31
    v_lshlrev_b32 v24, 16, v36
    v_and_b32 v25, 0xffff0000, v36
    v_lshlrev_b32 v26, 16, v37
    v_and_b32 v27, 0xffff0000, v37
    v_lshlrev_b32 v28, 16, v38
    v_and_b32 v29, 0xffff0000, v38
    v_lshlrev_b32 v30, 16, v39
    v_and_b32 v31, 0xffff0000, v39
    v_mul_f32 v168, v24, v21
    v_mul_f32 v169, v25, v21
    v_mul_f32 v170, v26, v21
    v_mul_f32 v171, v27, v21
    v_mul_f32 v172, v28, v21
    v_mul_f32 v173, v29, v21
    v_mul_f32 v174, v30, v21
    v_mul_f32 v175, v31, v21
    v_fma_f32 v24, -v168, v22, v24
    v_fma_f32 v25, -v169, v22, v25
    v_fma_f32 v26, -v170, v22, v26
    v_fma_f32 v27, -v171, v22, v27
    v_fma_f32 v28, -v172, v22, v28
    v_fma_f32 v29, -v173, v22, v29
    v_fma_f32 v30, -v174, v22, v30
    v_fma_f32 v31, -v175, v22, v31
    v_fma_f32 v168, v24, v21, v168
    v_fma_f32 v169, v25, v21, v169
    v_fma_f32 v170, v26, v21, v170
    v_fma_f32 v171, v27, v21, v171
    v_fma_f32 v172, v28, v21, v172
    v_fma_f32 v173, v29, v21, v173
    v_fma_f32 v174, v30, v21, v174
    v_fma_f32 v175, v31, v21, v175
    v_cvt_pk_bf16_f32 v36, v168, v169
    v_cvt_pk_bf16_f32 v37, v170, v171
    v_cvt_pk_bf16_f32 v38, v172, v173
    v_cvt_pk_bf16_f32 v39, v174, v175
    ds_write_b128 v17, v[36:39] offset:256
    s_mov_b64 exec, 1
    ds_add_rtn_u32 v15, v4, v5 offset:0
    s_waitcnt lgkmcnt(0)
    v_readfirstlane_b32 s67, v15
    s_cmp_eq_u32 s67, 3
    s_cbranch_scc1 L_bard_2

L_bar_1:
    ds_read_b32 v15, v4 offset:0
    s_waitcnt lgkmcnt(0)
    v_readfirstlane_b32 s67, v15
    s_cmp_lt_u32 s67, 4
    s_cbranch_scc1 L_bar_1

L_bard_2:
    s_mov_b64 exec, -1
    s_add_u32 s48, s58, 1
    s_add_u32 s96, s58, 2
    s_lshr_b32 s49, s48, 8
    s_lshr_b32 s50, s48, 16
    s_lshr_b32 s51, s48, 24
    s_lshr_b32 s97, s96, 8
    s_lshr_b32 s98, s96, 16
    s_lshr_b32 s99, s96, 24
    ds_read_b128 v[36:39], v18 offset:256
    s_and_b32 s60, s52, 1
    s_lshl_b32 s60, s60, 2
    s_lshr_b32 s61, s53, 3
    s_add_u32 s60, s60, s61
    s_mul_i32 s60, s60, 24576
    s_lshr_b32 s61, s52, 1
    s_mul_i32 s61, s61, 6144
    s_add_u32 s60, s60, s61
    s_add_u32 s71, s60, 4194304
    s_add_u32 s72, s71, 196608
    s_add_u32 s73, s71, 393216
    s_add_u32 s74, s71, 589824
    v_and_b32 v11, 0xff, v0
    v_lshlrev_b32 v19, 4, v11
    v_lshrrev_b32 v24, 4, v11
    v_mul_u32_u24 v24, 384, v24
    v_mul_u32_u24 v26, 43, v2
    v_lshrrev_b32 v26, 7, v26
    v_lshl_add_u32 v25, v26, 4, v24
    v_lshl_add_u32 v24, v2, 4, v24
    v_mul_u32_u24 v26, 3, v26
    v_sub_u32 v26, v2, v26
    v_lshrrev_b32 v7, 5, v11
    v_mul_u32_u24 v7, 272, v7
    v_and_b32 v12, 16, v0
    v_lshl_add_u32 v7, v12, 3, v7
    v_and_b32 v12, 1, v0
    v_lshl_add_u32 v7, v12, 6, v7
    v_and_b32 v12, 14, v0
    v_add_u32 v7, v7, v12

    s_waitcnt vmcnt(7)
    v_perm_b32 v72, v44, v40, s54
    v_perm_b32 v76, v44, v40, s55
    v_perm_b32 v80, v45, v41, s54
    v_perm_b32 v84, v45, v41, s55
    v_perm_b32 v88, v46, v42, s54
    v_perm_b32 v92, v46, v42, s55
    v_perm_b32 v96, v47, v43, s54
    v_perm_b32 v100, v47, v43, s55
    s_waitcnt vmcnt(5)
    v_perm_b32 v73, v52, v48, s54
    v_perm_b32 v77, v52, v48, s55
    v_perm_b32 v81, v53, v49, s54
    v_perm_b32 v85, v53, v49, s55
    v_perm_b32 v89, v54, v50, s54
    v_perm_b32 v93, v54, v50, s55
    v_perm_b32 v97, v55, v51, s54
    v_perm_b32 v101, v55, v51, s55
    s_waitcnt vmcnt(3)
    v_perm_b32 v74, v60, v56, s54
    v_perm_b32 v78, v60, v56, s55
    v_perm_b32 v82, v61, v57, s54
    v_perm_b32 v86, v61, v57, s55
    v_perm_b32 v90, v62, v58, s54
    v_perm_b32 v94, v62, v58, s55
    v_perm_b32 v98, v63, v59, s54
    v_perm_b32 v102, v63, v59, s55
    s_waitcnt vmcnt(1)
    v_perm_b32 v75, v68, v64, s54
    v_perm_b32 v79, v68, v64, s55
    v_perm_b32 v83, v69, v65, s54
    v_perm_b32 v87, v69, v65, s55
    v_perm_b32 v91, v70, v66, s54
    v_perm_b32 v95, v70, v66, s55
    v_perm_b32 v99, v71, v67, s54
    v_perm_b32 v103, v71, v67, s55
    s_waitcnt lgkmcnt(0)
    v_mfma_f32_16x16x32_bf16 v[136:139], v[72:75], v[36:39], 0
    v_mfma_f32_16x16x32_bf16 v[140:143], v[76:79], v[36:39], 0
    v_mfma_f32_16x16x32_bf16 v[144:147], v[80:83], v[36:39], 0
    v_mfma_f32_16x16x32_bf16 v[148:151], v[84:87], v[36:39], 0
    v_mfma_f32_16x16x32_bf16 v[152:155], v[88:91], v[36:39], 0
    v_mfma_f32_16x16x32_bf16 v[156:159], v[92:95], v[36:39], 0
    v_mfma_f32_16x16x32_bf16 v[160:163], v[96:99], v[36:39], 0
    v_mfma_f32_16x16x32_bf16 v[164:167], v[100:103], v[36:39], 0
    s_nop 0
    s_mov_b32 exec_lo, 0xff00ff
    s_mov_b32 exec_hi, 0xff00ff00
    ds_write_b128 v9, v[136:139] offset:4608
    ds_write_b128 v9, v[140:143] offset:4640
    ds_write_b128 v9, v[144:147] offset:4672
    ds_write_b128 v9, v[148:151] offset:4704
    ds_write_b128 v9, v[152:155] offset:4736
    ds_write_b128 v9, v[156:159] offset:4768
    ds_write_b128 v9, v[160:163] offset:4800
    ds_write_b128 v9, v[164:167] offset:4832
    s_mov_b64 exec, -1
    s_mov_b64 exec, 1
    ds_add_rtn_u32 v15, v4, v5 offset:4
    s_waitcnt lgkmcnt(0)
    v_readfirstlane_b32 s67, v15
    s_cmp_eq_u32 s67, 3
    s_cbranch_scc1 L_bard_4

L_bar_3:
    ds_read_b32 v15, v4 offset:4
    s_waitcnt lgkmcnt(0)
    v_readfirstlane_b32 s67, v15
    s_cmp_lt_u32 s67, 4
    s_cbranch_scc1 L_bar_3

L_bard_4:
    s_mov_b64 exec, -1
    ds_read_b128 v[136:139], v8 offset:4608
    ds_read_b128 v[140:143], v8 offset:6784
    ds_read_b128 v[144:147], v8 offset:8960
    ds_read_b128 v[148:151], v8 offset:11136
    s_waitcnt lgkmcnt(2)
    v_pk_add_f32 v[136:137], v[136:137], v[140:141]
    v_pk_add_f32 v[138:139], v[138:139], v[142:143]
    s_waitcnt lgkmcnt(0)
    v_pk_add_f32 v[144:145], v[144:145], v[148:149]
    v_pk_add_f32 v[146:147], v[146:147], v[150:151]
    v_pk_add_f32 v[136:137], v[136:137], v[144:145]
    v_pk_add_f32 v[138:139], v[138:139], v[146:147]
    v_mov_b32 v140, v136
    v_mov_b32 v141, v137
    v_mov_b32 v142, v138
    v_mov_b32 v143, v139
    v_permlane32_swap_b32 v136, v140
    v_permlane32_swap_b32 v137, v141
    v_permlane32_swap_b32 v138, v142
    v_permlane32_swap_b32 v139, v143
    v_add_f32 v136, v136, v140
    v_add_f32 v137, v137, v141
    v_add_f32 v138, v138, v142
    v_add_f32 v139, v139, v143
    s_mov_b32 exec_lo, 0
    v_mov_b32 v136, v139
    v_mov_b32_dpp v137, v139 row_shl:1 row_mask:0xf bank_mask:0xf
    v_mov_b32_dpp v138, v139 row_shl:2 row_mask:0xf bank_mask:0xf
    s_mov_b32 exec_lo, -1
    s_mov_b32 exec_hi, 0x92499249
    v_mov_b32 v139, s48

    buffer_store_dwordx4 v[136:139], v13, s[28:31], s70 offen offset:0 sc1
    s_mov_b64 exec, -1
    s_mov_b64 exec, 1
    ds_add_u32 v4, v5 offset:48
    s_mov_b64 exec, -1
L_lw_5:
    s_sleep 1
    ds_read_b32 v15, v4 offset:52
    s_waitcnt lgkmcnt(0)
    v_readfirstlane_b32 s67, v15
    s_cmp_lt_u32 s67, 4
    s_cbranch_scc1 L_lw_5

    buffer_load_dwordx4 v[168:171], v24, s[28:31], s71 offen offset:0 sc1
    buffer_load_dwordx4 v[172:175], v24, s[28:31], s72 offen offset:0 sc1
    buffer_load_dwordx4 v[176:179], v24, s[28:31], s73 offen offset:0 sc1
    buffer_load_dwordx4 v[180:183], v24, s[28:31], s74 offen offset:0 sc1
    buffer_load_dwordx4 v[184:187], v25, s[28:31], s71 offen offset:256 sc1
    buffer_load_dwordx4 v[188:191], v25, s[28:31], s72 offen offset:256 sc1
    buffer_load_dwordx4 v[192:195], v25, s[28:31], s73 offen offset:256 sc1
    buffer_load_dwordx4 v[196:199], v25, s[28:31], s74 offen offset:256 sc1
    s_mov_b64 exec, 1
    ds_add_u32 v4, v5 offset:44
    s_mov_b64 exec, -1
    s_mov_b32 s56, 0
    s_branch L_pollc_8
L_poll_6:
    buffer_load_dwordx4 v[168:171], v24, s[28:31], s71 offen offset:0 sc1
    buffer_load_dwordx4 v[172:175], v24, s[28:31], s72 offen offset:0 sc1
    buffer_load_dwordx4 v[176:179], v24, s[28:31], s73 offen offset:0 sc1
    buffer_load_dwordx4 v[180:183], v24, s[28:31], s74 offen offset:0 sc1
    buffer_load_dwordx4 v[184:187], v25, s[28:31], s71 offen offset:256 sc1
    buffer_load_dwordx4 v[188:191], v25, s[28:31], s72 offen offset:256 sc1
    buffer_load_dwordx4 v[192:195], v25, s[28:31], s73 offen offset:256 sc1
    buffer_load_dwordx4 v[196:199], v25, s[28:31], s74 offen offset:256 sc1
L_pollc_8:
    v_mov_b32 v16, 0
    s_waitcnt vmcnt(7)
    v_bitop3_b32 v16, v16, v171, s48 bitop3:0xf6
    s_waitcnt vmcnt(6)
    v_bitop3_b32 v16, v16, v175, s48 bitop3:0xf6
    s_waitcnt vmcnt(5)
    v_bitop3_b32 v16, v16, v179, s48 bitop3:0xf6
    s_waitcnt vmcnt(4)
    v_bitop3_b32 v16, v16, v183, s48 bitop3:0xf6
    s_waitcnt vmcnt(3)
    v_bitop3_b32 v16, v16, v187, s48 bitop3:0xf6
    s_waitcnt vmcnt(2)
    v_bitop3_b32 v16, v16, v191, s48 bitop3:0xf6
    s_waitcnt vmcnt(1)
    v_bitop3_b32 v16, v16, v195, s48 bitop3:0xf6
    s_waitcnt vmcnt(0)
    v_bitop3_b32 v16, v16, v199, s48 bitop3:0xf6
    v_cmp_ne_u32 vcc, 0, v16
    s_cbranch_vccz L_polld_7
    s_add_u32 s56, s56, 1

    s_cmp_lt_u32 s56, 400
    s_cbranch_scc1 L_poll_6
    buffer_wbl2 sc1
    s_waitcnt vmcnt(0)
    buffer_inv sc1
    s_waitcnt vmcnt(0)

    s_cmp_lt_u32 s56, 60400
    s_cbranch_scc1 L_poll_6
L_polld_7:
    v_pk_add_f32 v[168:169], v[168:169], v[172:173]
    v_pk_add_f32 v[170:171], v[170:171], v[174:175]
    v_pk_add_f32 v[176:177], v[176:177], v[180:181]
    v_pk_add_f32 v[178:179], v[178:179], v[182:183]
    v_pk_add_f32 v[168:169], v[168:169], v[176:177]
    v_pk_add_f32 v[170:171], v[170:171], v[178:179]
    v_pk_add_f32 v[184:185], v[184:185], v[188:189]
    v_pk_add_f32 v[186:187], v[186:187], v[190:191]
    v_pk_add_f32 v[192:193], v[192:193], v[196:197]
    v_pk_add_f32 v[194:195], v[194:195], v[198:199]
    v_pk_add_f32 v[184:185], v[184:185], v[192:193]
    v_pk_add_f32 v[186:187], v[186:187], v[194:195]
    v_cmp_eq_u32 vcc, 1, v26
    s_nop 1
    v_cndmask_b32 v171, v184, v185, vcc
    v_cmp_eq_u32 vcc, 2, v26
    s_nop 1
    v_cndmask_b32 v171, v171, v186, vcc

    v_cvt_pk_bf16_f32 v168, v168, v169
    v_cvt_pk_bf16_f32 v169, v170, v171
    ds_write_b16 v7, v168 offset:22016
    ds_write_b16_d16_hi v7, v168 offset:22032
    ds_write_b16 v7, v169 offset:22048
    ds_write_b16_d16_hi v7, v169 offset:22064

    s_mov_b64 exec, 1
    ds_add_u32 v4, v5 offset:8
    s_mov_b64 exec, -1
    v_mul_u32_u24 v7, 624, v10
    v_lshl_add_u32 v7, v3, 4, v7
    s_mul_i32 s60, s3, 4992
    v_add_u32 v7, s60, v7
    v_lshrrev_b32 v9, 3, v2
    v_lshlrev_b32 v8, 4, v10
    v_lshl_add_u32 v8, v3, 7, v8
    v_lshl_add_u32 v8, v9, 9, v8
    s_cmp_ge_u32 s53, 16
    s_cbranch_scc1 L_M1
    s_mov_b32 s36, s12
    s_mov_b32 s37, s13
    s_mov_b32 s38, 0x800000
    s_mov_b32 s39, 0x20000
    s_lshl_b32 s60, s53, 19
    s_lshr_b32 s61, s3, 1
    s_lshl_b32 s62, s61, 18
    s_add_u32 s60, s60, s62
    s_and_b32 s62, s3, 1
    s_lshl_b32 s63, s62, 13
    s_add_u32 s60, s60, s63
    s_lshl_b32 s63, s52, 8
    s_add_u32 s68, s60, s63
    v_lshlrev_b32 v17, 16, v3
    v_lshl_or_b32 v17, v2, 4, v17
    s_lshl_b32 s60, s53, 10
    s_lshl_b32 s61, s61, 9
    s_add_u32 s60, s60, s61
    s_lshl_b32 s62, s62, 8
    s_add_u32 s60, s60, s62
    s_add_u32 s72, s60, 589824
    v_lshlrev_b32 v18, 14, v10
    v_lshl_or_b32 v18, v3, 5, v18
    v_lshl_or_b32 v18, v9, 4, v18
    v_lshrrev_b32 v11, 3, v11
    v_mul_u32_u24 v12, 624, v10
    v_lshl_add_u32 v11, v11, 4, v12
    s_lshl_b32 s60, s52, 16
    s_lshl_b32 s61, s53, 12
    s_add_u32 s73, s60, 917504
    s_add_u32 s69, s73, s61
    s_lshl_b32 s61, s53, 8
    s_lshl_b32 s62, s3, 6
    s_add_u32 s61, s61, s62
    s_add_u32 s73, s73, s61
    v_lshlrev_b32 v14, 4, v3
    v_lshl_or_b32 v12, v2, 12, v14
    s_lshl_b32 s60, s52, 12
    s_add_u32 s60, s60, s61
    s_add_u32 s75, s60, 851968
    s_and_b32 s60, s3, 1
    s_lshl_b32 s60, s60, 13
    s_lshl_b32 s61, s52, 8
    s_add_u32 s60, s60, s61
    s_and_b32 s61, s53, 1
    s_lshl_b32 s61, s61, 7
    s_add_u32 s60, s60, s61
    s_lshr_b32 s61, s3, 1
    s_lshl_b32 s61, s61, 6
    s_add_u32 s60, s60, s61
    s_and_b32 s61, s53, 14
    s_add_u32 s60, s60, s61
    v_lshlrev_b32 v13, 11, v3

    buffer_load_ushort v192, v13, s[40:43], s60 offen offset:0
    buffer_load_ushort v193, v13, s[40:43], s60 offen offset:16
    buffer_load_ushort v194, v13, s[40:43], s60 offen offset:32
    buffer_load_ushort v195, v13, s[40:43], s60 offen offset:48
    buffer_load_dwordx4 v[196:199], v12, s[28:31], s73 offen offset:0 sc1
    buffer_load_dwordx4 v[168:171], v18, s[28:31], s72 offen offset:0 sc1
    buffer_load_dwordx4 v[172:175], v18, s[28:31], s72 offen offset:128 sc1
L_lw_9:
    s_sleep 1
    ds_read_b32 v15, v4 offset:32
    s_waitcnt lgkmcnt(0)
    v_readfirstlane_b32 s67, v15
    s_cmp_lt_u32 s67, 4
    s_cbranch_scc1 L_lw_9

    s_add_u32 s60, s68, 0x0
    buffer_load_dwordx4 v[40:43], v17, s[36:39], s60 offen nt
    s_add_u32 s60, s68, 0x4000
    buffer_load_dwordx4 v[44:47], v17, s[36:39], s60 offen nt
    s_add_u32 s60, s68, 0x8000
    buffer_load_dwordx4 v[48:51], v17, s[36:39], s60 offen nt
    s_add_u32 s60, s68, 0xc000
    buffer_load_dwordx4 v[52:55], v17, s[36:39], s60 offen nt
L_lw_10:
    s_sleep 1
    ds_read_b32 v15, v4 offset:20
    s_waitcnt lgkmcnt(0)
    v_readfirstlane_b32 s67, v15
    s_cmp_lt_u32 s67, 4
    s_cbranch_scc1 L_lw_10

    s_add_u32 s60, s68, 0x800
    buffer_load_dwordx4 v[56:59], v17, s[36:39], s60 offen nt
    s_add_u32 s60, s68, 0x4800
    buffer_load_dwordx4 v[60:63], v17, s[36:39], s60 offen nt
    s_add_u32 s60, s68, 0x8800
    buffer_load_dwordx4 v[64:67], v17, s[36:39], s60 offen nt
    s_add_u32 s60, s68, 0xc800
    buffer_load_dwordx4 v[68:71], v17, s[36:39], s60 offen nt
    s_add_u32 s60, s68, 0x1000
    buffer_load_dwordx4 v[104:107], v17, s[36:39], s60 offen nt
    s_add_u32 s60, s68, 0x5000
    buffer_load_dwordx4 v[108:111], v17, s[36:39], s60 offen nt
    s_add_u32 s60, s68, 0x9000
    buffer_load_dwordx4 v[112:115], v17, s[36:39], s60 offen nt
    s_add_u32 s60, s68, 0xd000
    buffer_load_dwordx4 v[116:119], v17, s[36:39], s60 offen nt
    s_add_u32 s60, s68, 0x1800
    buffer_load_dwordx4 v[120:123], v17, s[36:39], s60 offen nt
    s_add_u32 s60, s68, 0x5800
    buffer_load_dwordx4 v[124:127], v17, s[36:39], s60 offen nt
    s_add_u32 s60, s68, 0x9800
    buffer_load_dwordx4 v[128:131], v17, s[36:39], s60 offen nt
    s_add_u32 s60, s68, 0xd800
    buffer_load_dwordx4 v[132:135], v17, s[36:39], s60 offen nt
    s_waitcnt vmcnt(14)
    v_perm_b32 v72, v44, v40, s54
    v_perm_b32 v76, v44, v40, s55
    v_perm_b32 v80, v45, v41, s54
    v_perm_b32 v84, v45, v41, s55
    v_perm_b32 v88, v46, v42, s54
    v_perm_b32 v92, v46, v42, s55
    v_perm_b32 v96, v47, v43, s54
    v_perm_b32 v100, v47, v43, s55
    s_waitcnt vmcnt(12)
    v_perm_b32 v73, v52, v48, s54
    v_perm_b32 v77, v52, v48, s55
    v_perm_b32 v81, v53, v49, s54
    v_perm_b32 v85, v53, v49, s55
    v_perm_b32 v89, v54, v50, s54
    v_perm_b32 v93, v54, v50, s55
    v_perm_b32 v97, v55, v51, s54
    v_perm_b32 v101, v55, v51, s55
    s_waitcnt vmcnt(10)
    v_perm_b32 v74, v60, v56, s54
    v_perm_b32 v78, v60, v56, s55
    v_perm_b32 v82, v61, v57, s54
    v_perm_b32 v86, v61, v57, s55
    v_perm_b32 v90, v62, v58, s54
    v_perm_b32 v94, v62, v58, s55
    v_perm_b32 v98, v63, v59, s54
    v_perm_b32 v102, v63, v59, s55
    s_waitcnt vmcnt(8)
    v_perm_b32 v75, v68, v64, s54
    v_perm_b32 v79, v68, v64, s55
    v_perm_b32 v83, v69, v65, s54
    v_perm_b32 v87, v69, v65, s55
    v_perm_b32 v91, v70, v66, s54
    v_perm_b32 v95, v70, v66, s55
    v_perm_b32 v99, v71, v67, s54
    v_perm_b32 v103, v71, v67, s55
    s_waitcnt vmcnt(6)
    v_perm_b32 v40, v108, v104, s54
    v_perm_b32 v44, v108, v104, s55
    v_perm_b32 v48, v109, v105, s54
    v_perm_b32 v52, v109, v105, s55
    v_perm_b32 v56, v110, v106, s54
    v_perm_b32 v60, v110, v106, s55
    v_perm_b32 v64, v111, v107, s54
    v_perm_b32 v68, v111, v107, s55
    s_waitcnt vmcnt(4)
    v_perm_b32 v41, v116, v112, s54
    v_perm_b32 v45, v116, v112, s55
    v_perm_b32 v49, v117, v113, s54
    v_perm_b32 v53, v117, v113, s55
    v_perm_b32 v57, v118, v114, s54
    v_perm_b32 v61, v118, v114, s55
    v_perm_b32 v65, v119, v115, s54
    v_perm_b32 v69, v119, v115, s55
    s_waitcnt vmcnt(2)
    v_perm_b32 v42, v124, v120, s54
    v_perm_b32 v46, v124, v120, s55
    v_perm_b32 v50, v125, v121, s54
    v_perm_b32 v54, v125, v121, s55
    v_perm_b32 v58, v126, v122, s54
    v_perm_b32 v62, v126, v122, s55
    v_perm_b32 v66, v127, v123, s54
    v_perm_b32 v70, v127, v123, s55
    s_waitcnt vmcnt(0)
    v_perm_b32 v43, v132, v128, s54
    v_perm_b32 v47, v132, v128, s55
    v_perm_b32 v51, v133, v129, s54
    v_perm_b32 v55, v133, v129, s55
    v_perm_b32 v59, v134, v130, s54
    v_perm_b32 v63, v134, v130, s55
    v_perm_b32 v67, v135, v131, s54
    v_perm_b32 v71, v135, v131, s55
    v_lshlrev_b32 v192, 16, v192
    v_lshlrev_b32 v193, 16, v193
    v_lshlrev_b32 v194, 16, v194
    v_lshlrev_b32 v195, 16, v195
    s_mov_b32 s56, 0
L_poll_11:
    buffer_load_dwordx4 v[168:171], v18, s[28:31], s72 offen offset:0 sc1
    buffer_load_dwordx4 v[172:175], v18, s[28:31], s72 offen offset:128 sc1
L_pollc_13:
    v_mov_b32 v16, 0
    s_waitcnt vmcnt(1)
    v_bitop3_b32 v16, v16, v168, s48 bitop3:0xf6
    v_bitop3_b32 v16, v16, v169, s49 bitop3:0xf6
    v_bitop3_b32 v16, v16, v170, s50 bitop3:0xf6
    v_bitop3_b32 v16, v16, v171, s51 bitop3:0xf6
    s_waitcnt vmcnt(0)
    v_bitop3_b32 v16, v16, v172, s48 bitop3:0xf6
    v_bitop3_b32 v16, v16, v173, s49 bitop3:0xf6
    v_bitop3_b32 v16, v16, v174, s50 bitop3:0xf6
    v_bitop3_b32 v16, v16, v175, s51 bitop3:0xf6
    v_and_b32 v16, 0xff, v16
    v_cmp_ne_u32 vcc, 0, v16
    s_cbranch_vccz L_polld_12
    s_add_u32 s56, s56, 1

    s_cmp_lt_u32 s56, 400
    s_cbranch_scc1 L_poll_11
    buffer_wbl2 sc1
    s_waitcnt vmcnt(0)
    buffer_inv sc1
    s_waitcnt vmcnt(0)

    s_cmp_lt_u32 s56, 60400
    s_cbranch_scc1 L_poll_11
L_polld_12:
    v_perm_b32 v184, v169, v168, s55
    v_perm_b32 v185, v171, v170, s55
    v_perm_b32 v188, v173, v172, s55
    v_perm_b32 v189, v175, v174, s55
    v_mov_b32_dpp v186, v184 row_ror:8 row_mask:0xf bank_mask:0xf
    v_mov_b32_dpp v187, v185 row_ror:8 row_mask:0xf bank_mask:0xf
    v_mov_b32_dpp v190, v188 row_ror:8 row_mask:0xf bank_mask:0xf
    v_mov_b32_dpp v191, v189 row_ror:8 row_mask:0xf bank_mask:0xf
    v_mfma_f32_16x16x32_bf16 v[136:139], v[72:75], v[184:187], 0
    v_mfma_f32_16x16x32_bf16 v[140:143], v[76:79], v[184:187], 0
    v_mfma_f32_16x16x32_bf16 v[144:147], v[80:83], v[184:187], 0
    v_mfma_f32_16x16x32_bf16 v[148:151], v[84:87], v[184:187], 0
    v_mfma_f32_16x16x32_bf16 v[152:155], v[88:91], v[184:187], 0
    v_mfma_f32_16x16x32_bf16 v[156:159], v[92:95], v[184:187], 0
    v_mfma_f32_16x16x32_bf16 v[160:163], v[96:99], v[184:187], 0
    v_mfma_f32_16x16x32_bf16 v[164:167], v[100:103], v[184:187], 0
    v_mfma_f32_16x16x32_bf16 v[136:139], v[40:43], v[188:191], v[136:139]
    v_mfma_f32_16x16x32_bf16 v[140:143], v[44:47], v[188:191], v[140:143]
    v_mfma_f32_16x16x32_bf16 v[144:147], v[48:51], v[188:191], v[144:147]
    v_mfma_f32_16x16x32_bf16 v[148:151], v[52:55], v[188:191], v[148:151]
    v_mfma_f32_16x16x32_bf16 v[152:155], v[56:59], v[188:191], v[152:155]
    v_mfma_f32_16x16x32_bf16 v[156:159], v[60:63], v[188:191], v[156:159]
    v_mfma_f32_16x16x32_bf16 v[160:163], v[64:67], v[188:191], v[160:163]
    v_mfma_f32_16x16x32_bf16 v[164:167], v[68:71], v[188:191], v[164:167]
    s_nop 0
    s_mov_b32 exec_lo, 0xff00ff
    s_mov_b32 exec_hi, 0xff00ff
    ds_write_b128 v7, v[136:139] offset:44672
    ds_write_b128 v7, v[140:143] offset:44736
    ds_write_b128 v7, v[144:147] offset:44800
    ds_write_b128 v7, v[148:151] offset:44864
    ds_write_b128 v7, v[152:155] offset:44928
    ds_write_b128 v7, v[156:159] offset:44992
    ds_write_b128 v7, v[160:163] offset:45056
    ds_write_b128 v7, v[164:167] offset:45120
    s_mov_b64 exec, -1
    s_waitcnt lgkmcnt(0)
    s_barrier
    ds_read_b128 v[136:139], v11 offset:44672
    ds_read_b128 v[140:143], v11 offset:49664
    ds_read_b128 v[144:147], v11 offset:54656
    ds_read_b128 v[148:151], v11 offset:59648
    s_waitcnt lgkmcnt(2)
    v_pk_add_f32 v[136:137], v[136:137], v[140:141]
    v_pk_add_f32 v[138:139], v[138:139], v[142:143]
    s_waitcnt lgkmcnt(0)
    v_pk_add_f32 v[144:145], v[144:145], v[148:149]
    v_pk_add_f32 v[146:147], v[146:147], v[150:151]
    v_pk_add_f32 v[136:137], v[136:137], v[144:145]
    v_pk_add_f32 v[138:139], v[138:139], v[146:147]
    v_add_u32 v136, 0x80, v136
    v_add_u32 v137, 0x80, v137
    v_add_u32 v138, 0x80, v138
    v_add_u32 v139, 0x80, v139
    v_bfi_b32 v136, v6, s48, v136
    v_bfi_b32 v137, v6, s49, v137
    v_bfi_b32 v138, v6, s50, v138
    v_bfi_b32 v139, v6, s51, v139
    buffer_store_dwordx4 v[136:139], v19, s[28:31], s69 offen offset:0
    s_mov_b32 s56, 0
L_poll_14:
    buffer_load_dwordx4 v[196:199], v12, s[28:31], s73 offen offset:0 sc1
L_pollc_16:
    v_mov_b32 v16, 0
    s_waitcnt vmcnt(0)
    v_bitop3_b32 v16, v16, v196, s48 bitop3:0xf6
    v_bitop3_b32 v16, v16, v197, s49 bitop3:0xf6
    v_bitop3_b32 v16, v16, v198, s50 bitop3:0xf6
    v_bitop3_b32 v16, v16, v199, s51 bitop3:0xf6
    v_and_b32 v16, 0xff, v16
    v_cmp_ne_u32 vcc, 0, v16
    s_cbranch_vccz L_polld_15
    s_add_u32 s56, s56, 1

    s_cmp_lt_u32 s56, 400
    s_cbranch_scc1 L_poll_14
    buffer_wbl2 sc1
    s_waitcnt vmcnt(0)
    buffer_inv sc1
    s_waitcnt vmcnt(0)

    s_cmp_lt_u32 s56, 60400
    s_cbranch_scc1 L_poll_14
L_polld_15:
    v_and_b32 v196, 0xffffff00, v196
    v_and_b32 v197, 0xffffff00, v197
    v_and_b32 v198, 0xffffff00, v198
    v_and_b32 v199, 0xffffff00, v199
    v_add_f32_dpp v196, v196, v196 quad_perm:[1,0,3,2] row_mask:0xf bank_mask:0xf
    v_add_f32_dpp v197, v197, v197 quad_perm:[1,0,3,2] row_mask:0xf bank_mask:0xf
    v_add_f32_dpp v198, v198, v198 quad_perm:[1,0,3,2] row_mask:0xf bank_mask:0xf
    v_add_f32_dpp v199, v199, v199 quad_perm:[1,0,3,2] row_mask:0xf bank_mask:0xf
    v_add_f32_dpp v196, v196, v196 quad_perm:[2,3,0,1] row_mask:0xf bank_mask:0xf
    v_add_f32_dpp v197, v197, v197 quad_perm:[2,3,0,1] row_mask:0xf bank_mask:0xf
    v_add_f32_dpp v198, v198, v198 quad_perm:[2,3,0,1] row_mask:0xf bank_mask:0xf
    v_add_f32_dpp v199, v199, v199 quad_perm:[2,3,0,1] row_mask:0xf bank_mask:0xf
    v_add_f32_dpp v196, v196, v196 row_half_mirror row_mask:0xf bank_mask:0xf
    v_add_f32_dpp v197, v197, v197 row_half_mirror row_mask:0xf bank_mask:0xf
    v_add_f32_dpp v198, v198, v198 row_half_mirror row_mask:0xf bank_mask:0xf
    v_add_f32_dpp v199, v199, v199 row_half_mirror row_mask:0xf bank_mask:0xf
    v_add_f32_dpp v196, v196, v196 row_mirror row_mask:0xf bank_mask:0xf
    v_add_f32_dpp v197, v197, v197 row_mirror row_mask:0xf bank_mask:0xf
    v_add_f32_dpp v198, v198, v198 row_mirror row_mask:0xf bank_mask:0xf
    v_add_f32_dpp v199, v199, v199 row_mirror row_mask:0xf bank_mask:0xf
    v_cvt_pk_bf16_f32 v168, v196, v197
    v_cvt_pk_bf16_f32 v169, v198, v199
    v_lshlrev_b32 v196, 16, v168
    v_and_b32 v197, 0xffff0000, v168
    v_lshlrev_b32 v198, 16, v169
    v_and_b32 v199, 0xffff0000, v169
    v_pk_add_f32 v[196:197], v[196:197], v[192:193]
    v_pk_add_f32 v[198:199], v[198:199], v[194:195]
    v_cvt_pk_bf16_f32 v168, v196, v197
    v_cvt_pk_bf16_f32 v169, v198, v199
    v_perm_b32 v196, v168, s48, v232
    v_perm_b32 v197, v168, s48, v233
    v_perm_b32 v198, v169, s48, v234
    v_perm_b32 v199, v169, s48, v235
    s_mov_b32 exec_lo, 0x10001
    s_mov_b32 exec_hi, 0x10001
    buffer_store_dwordx4 v[196:199], v14, s[28:31], s75 offen offset:0
    s_mov_b64 exec, -1
    s_mov_b64 exec, 1
    ds_add_u32 v4, v5 offset:24
    s_mov_b64 exec, -1
    s_branch L_Bend
L_rsdone:
    s_branch L_Bend
L_M1:
    s_cmp_lt_u32 s53, 24
    s_cbranch_scc1 L_noC
    s_sub_u32 s60, s53, 24
    s_lshr_b32 s61, s60, 1
    s_and_b32 s60, s60, 1
    s_lshl_b32 s60, s60, 2
    s_add_u32 s60, s60, s3
    s_lshl_b32 s62, s61, 6
    s_add_u32 s62, s62, s52
    s_lshl_b32 s63, s62, 9
    s_lshl_b32 s64, s60, 4
    s_add_u32 s63, s63, s64
    s_add_u32 s68, s63, 2490368
    s_lshl_b32 s63, s62, 12
    s_lshl_b32 s64, s60, 9
    s_add_u32 s63, s63, s64
    s_add_u32 s69, s63, 1441792
    s_add_u32 s70, s69, 0x10000
    s_add_u32 s71, s69, 0x20000
    s_add_u32 s72, s69, 0x30000
    v_and_b32 v11, 7, v1
    v_lshlrev_b32 v11, 12, v11
    v_and_b32 v12, 24, v1
    v_lshl_or_b32 v11, v12, 4, v11
    v_lshrrev_b32 v12, 5, v1
    v_and_b32 v13, 31, v1
    v_lshlrev_b32 v13, 4, v13
    v_lshl_or_b32 v14, v12, 15, v13
    s_and_b32 s63, s52, 1
    s_lshl_b32 s63, s63, 2
    s_add_u32 s63, s63, s61
    s_lshl_b32 s63, s63, 5
    s_lshr_b32 s64, s52, 1
    s_lshl_b32 s64, s64, 3
    s_add_u32 s63, s63, s64
    s_add_u32 s63, s63, s60
    s_lshl_b32 s63, s63, 9
    s_add_u32 s73, s63, 589824
    s_mov_b32 s66, 0x3fb8aa3b
    v_lshlrev_b32 v12, 2, v12

    buffer_load_dwordx4 v[184:187], v11, s[28:31], s68 offen offset:0 sc1
    buffer_load_dwordx4 v[168:171], v14, s[28:31], s69 offen offset:0 sc1
    buffer_load_dwordx4 v[172:175], v14, s[28:31], s70 offen offset:0 sc1
    buffer_load_dwordx4 v[176:179], v14, s[28:31], s71 offen offset:0 sc1
    buffer_load_dwordx4 v[180:183], v14, s[28:31], s72 offen offset:0 sc1
L_lw_17:
    s_sleep 1
    ds_read_b32 v15, v4 offset:20
    s_waitcnt lgkmcnt(0)
    v_readfirstlane_b32 s67, v15
    s_cmp_lt_u32 s67, 1
    s_cbranch_scc1 L_lw_17

    s_mov_b32 s56, 0
L_poll_18:
    buffer_load_dwordx4 v[184:187], v11, s[28:31], s68 offen offset:0 sc1
    buffer_load_dwordx4 v[168:171], v14, s[28:31], s69 offen offset:0 sc1
    buffer_load_dwordx4 v[172:175], v14, s[28:31], s70 offen offset:0 sc1
    buffer_load_dwordx4 v[176:179], v14, s[28:31], s71 offen offset:0 sc1
    buffer_load_dwordx4 v[180:183], v14, s[28:31], s72 offen offset:0 sc1
L_pollc_20:
    v_mov_b32 v16, 0
    s_waitcnt vmcnt(4)
    v_bitop3_b32 v16, v16, v184, s48 bitop3:0xf6
    v_bitop3_b32 v16, v16, v185, s49 bitop3:0xf6
    v_bitop3_b32 v16, v16, v186, s50 bitop3:0xf6
    v_bitop3_b32 v16, v16, v187, s51 bitop3:0xf6
    v_and_b32 v16, 0xff, v16
    v_cmp_ne_u32 vcc, 0, v16
    s_cbranch_vccz L_polld_19
    s_add_u32 s56, s56, 1

    s_cmp_lt_u32 s56, 400
    s_cbranch_scc1 L_poll_18
    buffer_wbl2 sc1
    s_waitcnt vmcnt(0)
    buffer_inv sc1
    s_waitcnt vmcnt(0)

    s_cmp_lt_u32 s56, 60400
    s_cbranch_scc1 L_poll_18
L_polld_19:
    v_and_b32 v184, 0xffffff00, v184
    v_and_b32 v185, 0xffffff00, v185
    v_mov_b32 v186, v184
    s_nop 1
    v_max_f32_dpp v186, v186, v186 row_ror:8 row_mask:0xf bank_mask:0xf
    v_mov_b32 v187, v186
    s_nop 1
    v_permlane16_swap_b32 v186, v187
    v_max_f32 v186, v186, v187
    v_mov_b32 v187, v186
    s_nop 1
    v_max_f32_dpp v187, v187, v187 quad_perm:[1,0,3,2] row_mask:0xf bank_mask:0xf
    s_nop 1
    v_max_f32_dpp v187, v187, v187 quad_perm:[2,3,0,1] row_mask:0xf bank_mask:0xf
    s_nop 1
    v_max_f32_dpp v187, v187, v187 row_half_mirror row_mask:0xf bank_mask:0xf
    v_sub_f32 v184, v184, v187
    v_sub_f32 v186, v186, v187
    v_mul_f32 v184, s66, v184
    v_mul_f32 v186, s66, v186
    v_exp_f32 v184, v184
    v_exp_f32 v186, v186
    v_mul_f32 v185, v185, v184

    s_nop 1
    v_add_f32_dpp v185, v185, v185 quad_perm:[1,0,3,2] row_mask:0xf bank_mask:0xf
    s_nop 1
    v_add_f32_dpp v185, v185, v185 quad_perm:[2,3,0,1] row_mask:0xf bank_mask:0xf
    s_nop 1
    v_add_f32_dpp v185, v185, v185 row_half_mirror row_mask:0xf bank_mask:0xf
    s_nop 1
    v_add_f32_dpp v185, v185, v185 row_mirror row_mask:0xf bank_mask:0xf
    v_mov_b32 v187, v185
    s_nop 1
    v_permlane16_swap_b32 v185, v187
    v_add_f32 v185, v185, v187
    v_rcp_f32 v184, v185
    s_nop 0
    v_fma_f32 v187, -v185, v184, 1.0
    v_fma_f32 v184, v187, v184, v184
    v_mul_f32 v184, v184, v186

    ds_bpermute_b32 v188, v12, v184 offset:0
    ds_bpermute_b32 v189, v12, v184 offset:8
    ds_bpermute_b32 v190, v12, v184 offset:16
    ds_bpermute_b32 v191, v12, v184 offset:24
    s_mov_b32 s56, 0
    s_branch L_pollc_23
L_poll_21:
    buffer_load_dwordx4 v[168:171], v14, s[28:31], s69 offen offset:0 sc1
    buffer_load_dwordx4 v[172:175], v14, s[28:31], s70 offen offset:0 sc1
    buffer_load_dwordx4 v[176:179], v14, s[28:31], s71 offen offset:0 sc1
    buffer_load_dwordx4 v[180:183], v14, s[28:31], s72 offen offset:0 sc1
L_pollc_23:
    v_mov_b32 v16, 0
    s_waitcnt vmcnt(3)
    v_bitop3_b32 v16, v16, v168, s48 bitop3:0xf6
    v_bitop3_b32 v16, v16, v169, s49 bitop3:0xf6
    v_bitop3_b32 v16, v16, v170, s50 bitop3:0xf6
    v_bitop3_b32 v16, v16, v171, s51 bitop3:0xf6
    s_waitcnt vmcnt(2)
    v_bitop3_b32 v16, v16, v172, s48 bitop3:0xf6
    v_bitop3_b32 v16, v16, v173, s49 bitop3:0xf6
    v_bitop3_b32 v16, v16, v174, s50 bitop3:0xf6
    v_bitop3_b32 v16, v16, v175, s51 bitop3:0xf6
    s_waitcnt vmcnt(1)
    v_bitop3_b32 v16, v16, v176, s48 bitop3:0xf6
    v_bitop3_b32 v16, v16, v177, s49 bitop3:0xf6
    v_bitop3_b32 v16, v16, v178, s50 bitop3:0xf6
    v_bitop3_b32 v16, v16, v179, s51 bitop3:0xf6
    s_waitcnt vmcnt(0)
    v_bitop3_b32 v16, v16, v180, s48 bitop3:0xf6
    v_bitop3_b32 v16, v16, v181, s49 bitop3:0xf6
    v_bitop3_b32 v16, v16, v182, s50 bitop3:0xf6
    v_bitop3_b32 v16, v16, v183, s51 bitop3:0xf6
    v_and_b32 v16, 0xff, v16
    v_cmp_ne_u32 vcc, 0, v16
    s_cbranch_vccz L_polld_22
    s_add_u32 s56, s56, 1

    s_cmp_lt_u32 s56, 400
    s_cbranch_scc1 L_poll_21
    buffer_wbl2 sc1
    s_waitcnt vmcnt(0)
    buffer_inv sc1
    s_waitcnt vmcnt(0)

    s_cmp_lt_u32 s56, 60400
    s_cbranch_scc1 L_poll_21
L_polld_22:
    v_and_b32 v168, 0xffffff00, v168
    v_and_b32 v169, 0xffffff00, v169
    v_and_b32 v170, 0xffffff00, v170
    v_and_b32 v171, 0xffffff00, v171
    v_and_b32 v172, 0xffffff00, v172
    v_and_b32 v173, 0xffffff00, v173
    v_and_b32 v174, 0xffffff00, v174
    v_and_b32 v175, 0xffffff00, v175
    v_and_b32 v176, 0xffffff00, v176
    v_and_b32 v177, 0xffffff00, v177
    v_and_b32 v178, 0xffffff00, v178
    v_and_b32 v179, 0xffffff00, v179
    v_and_b32 v180, 0xffffff00, v180
    v_and_b32 v181, 0xffffff00, v181
    v_and_b32 v182, 0xffffff00, v182
    v_and_b32 v183, 0xffffff00, v183
    s_waitcnt lgkmcnt(0)
    v_mul_f32 v168, v168, v188
    v_mul_f32 v169, v169, v188
    v_mul_f32 v170, v170, v188
    v_mul_f32 v171, v171, v188
    v_fmac_f32 v168, v172, v189
    v_fmac_f32 v169, v173, v189
    v_fmac_f32 v170, v174, v189
    v_fmac_f32 v171, v175, v189
    v_fmac_f32 v168, v176, v190
    v_fmac_f32 v169, v177, v190
    v_fmac_f32 v170, v178, v190
    v_fmac_f32 v171, v179, v190
    v_fmac_f32 v168, v180, v191
    v_fmac_f32 v169, v181, v191
    v_fmac_f32 v170, v182, v191
    v_fmac_f32 v171, v183, v191
    v_mov_b32 v172, v168
    v_mov_b32 v173, v169
    v_mov_b32 v174, v170
    v_mov_b32 v175, v171
    v_permlane32_swap_b32 v168, v172
    v_permlane32_swap_b32 v169, v173
    v_permlane32_swap_b32 v170, v174
    v_permlane32_swap_b32 v171, v175
    v_add_f32 v168, v168, v172
    v_add_f32 v169, v169, v173
    v_add_f32 v170, v170, v174
    v_add_f32 v171, v171, v175
    v_cvt_pk_bf16_f32 v172, v168, v169
    v_cvt_pk_bf16_f32 v173, v170, v171
    v_perm_b32 v168, v172, s48, v232
    v_perm_b32 v169, v172, s48, v233
    v_perm_b32 v170, v173, s48, v234
    v_perm_b32 v171, v173, s48, v235
    s_mov_b32 exec_hi, 0
    buffer_store_dwordx4 v[168:171], v13, s[28:31], s73 offen offset:0 sc1
    s_mov_b64 exec, -1
    s_cmp_lt_u32 s53, 30
    s_cbranch_scc1 L_W1
    s_branch L_Bend
L_noC:
L_lw_24:
    s_sleep 1
    ds_read_b32 v15, v4 offset:32
    s_waitcnt lgkmcnt(0)
    v_readfirstlane_b32 s67, v15
    s_cmp_lt_u32 s67, 4
    s_cbranch_scc1 L_lw_24

L_W1:
    s_mov_b32 s36, s16
    s_mov_b32 s37, s17
    s_mov_b32 s38, 0x700000
    s_mov_b32 s39, 0x20000
    s_sub_u32 s64, s53, 16
    s_mul_i32 s60, s52, 917504
    s_lshr_b32 s61, s3, 1
    s_mul_i32 s62, s61, 28672
    s_add_u32 s60, s60, s62
    s_lshl_b32 s62, s64, 9
    s_add_u32 s60, s60, s62
    s_and_b32 s63, s3, 1
    s_lshl_b32 s62, s63, 8
    s_add_u32 s68, s60, s62
    v_mul_u32_u24 v17, 229376, v3
    v_lshl_add_u32 v17, v2, 4, v17
    s_add_u32 s60, s68, 0x0
    buffer_load_dwordx4 v[40:43], v17, s[36:39], s60 offen nt
    s_add_u32 s60, s68, 0xe000
    buffer_load_dwordx4 v[44:47], v17, s[36:39], s60 offen nt
    s_add_u32 s60, s68, 0x1c000
    buffer_load_dwordx4 v[48:51], v17, s[36:39], s60 offen nt
    s_add_u32 s60, s68, 0x2a000
    buffer_load_dwordx4 v[52:55], v17, s[36:39], s60 offen nt
    s_cmp_ge_u32 s53, 24
    s_cbranch_scc1 L_mmid_25
L_lw_26:
    s_sleep 1
    ds_read_b32 v15, v4 offset:20
    s_waitcnt lgkmcnt(0)
    v_readfirstlane_b32 s67, v15
    s_cmp_lt_u32 s67, 4
    s_cbranch_scc1 L_lw_26

L_mmid_25:
    s_add_u32 s60, s68, 0x1c00
    buffer_load_dwordx4 v[56:59], v17, s[36:39], s60 offen nt
    s_add_u32 s60, s68, 0xfc00
    buffer_load_dwordx4 v[60:63], v17, s[36:39], s60 offen nt
    s_add_u32 s60, s68, 0x1dc00
    buffer_load_dwordx4 v[64:67], v17, s[36:39], s60 offen nt
    s_add_u32 s60, s68, 0x2bc00
    buffer_load_dwordx4 v[68:71], v17, s[36:39], s60 offen nt
    s_add_u32 s60, s68, 0x3800
    buffer_load_dwordx4 v[104:107], v17, s[36:39], s60 offen nt
    s_add_u32 s60, s68, 0x11800
    buffer_load_dwordx4 v[108:111], v17, s[36:39], s60 offen nt
    s_add_u32 s60, s68, 0x1f800
    buffer_load_dwordx4 v[112:115], v17, s[36:39], s60 offen nt
    s_add_u32 s60, s68, 0x2d800
    buffer_load_dwordx4 v[116:119], v17, s[36:39], s60 offen nt
    s_add_u32 s60, s68, 0x5400
    buffer_load_dwordx4 v[120:123], v17, s[36:39], s60 offen nt
    s_add_u32 s60, s68, 0x13400
    buffer_load_dwordx4 v[124:127], v17, s[36:39], s60 offen nt
    s_add_u32 s60, s68, 0x21400
    buffer_load_dwordx4 v[128:131], v17, s[36:39], s60 offen nt
    s_add_u32 s60, s68, 0x2f400
    buffer_load_dwordx4 v[132:135], v17, s[36:39], s60 offen nt
    s_mov_b64 exec, 1
    ds_add_u32 v4, v5 offset:36
    s_mov_b64 exec, -1
    s_waitcnt vmcnt(14)
    v_perm_b32 v72, v44, v40, s54
    v_perm_b32 v76, v44, v40, s55
    v_perm_b32 v80, v45, v41, s54
    v_perm_b32 v84, v45, v41, s55
    v_perm_b32 v88, v46, v42, s54
    v_perm_b32 v92, v46, v42, s55
    v_perm_b32 v96, v47, v43, s54
    v_perm_b32 v100, v47, v43, s55
    s_waitcnt vmcnt(12)
    v_perm_b32 v73, v52, v48, s54
    v_perm_b32 v77, v52, v48, s55
    v_perm_b32 v81, v53, v49, s54
    v_perm_b32 v85, v53, v49, s55
    v_perm_b32 v89, v54, v50, s54
    v_perm_b32 v93, v54, v50, s55
    v_perm_b32 v97, v55, v51, s54
    v_perm_b32 v101, v55, v51, s55
    s_waitcnt vmcnt(10)
    v_perm_b32 v74, v60, v56, s54
    v_perm_b32 v78, v60, v56, s55
    v_perm_b32 v82, v61, v57, s54
    v_perm_b32 v86, v61, v57, s55
    v_perm_b32 v90, v62, v58, s54
    v_perm_b32 v94, v62, v58, s55
    v_perm_b32 v98, v63, v59, s54
    v_perm_b32 v102, v63, v59, s55
    s_waitcnt vmcnt(8)
    v_perm_b32 v75, v68, v64, s54
    v_perm_b32 v79, v68, v64, s55
    v_perm_b32 v83, v69, v65, s54
    v_perm_b32 v87, v69, v65, s55
    v_perm_b32 v91, v70, v66, s54
    v_perm_b32 v95, v70, v66, s55
    v_perm_b32 v99, v71, v67, s54
    v_perm_b32 v103, v71, v67, s55
    s_waitcnt vmcnt(6)
    v_perm_b32 v40, v108, v104, s54
    v_perm_b32 v44, v108, v104, s55
    v_perm_b32 v48, v109, v105, s54
    v_perm_b32 v52, v109, v105, s55
    v_perm_b32 v56, v110, v106, s54
    v_perm_b32 v60, v110, v106, s55
    v_perm_b32 v64, v111, v107, s54
    v_perm_b32 v68, v111, v107, s55
    s_waitcnt vmcnt(4)
    v_perm_b32 v41, v116, v112, s54
    v_perm_b32 v45, v116, v112, s55
    v_perm_b32 v49, v117, v113, s54
    v_perm_b32 v53, v117, v113, s55
    v_perm_b32 v57, v118, v114, s54
    v_perm_b32 v61, v118, v114, s55
    v_perm_b32 v65, v119, v115, s54
    v_perm_b32 v69, v119, v115, s55
    s_waitcnt vmcnt(2)
    v_perm_b32 v42, v124, v120, s54
    v_perm_b32 v46, v124, v120, s55
    v_perm_b32 v50, v125, v121, s54
    v_perm_b32 v54, v125, v121, s55
    v_perm_b32 v58, v126, v122, s54
    v_perm_b32 v62, v126, v122, s55
    v_perm_b32 v66, v127, v123, s54
    v_perm_b32 v70, v127, v123, s55
    s_waitcnt vmcnt(0)
    v_perm_b32 v43, v132, v128, s54
    v_perm_b32 v47, v132, v128, s55
    v_perm_b32 v51, v133, v129, s54
    v_perm_b32 v55, v133, v129, s55
    v_perm_b32 v59, v134, v130, s54
    v_perm_b32 v63, v134, v130, s55
    v_perm_b32 v67, v135, v131, s54
    v_perm_b32 v71, v135, v131, s55
    v_mov_b32 v168, s59
    v_mov_b32 v169, s59
    v_mov_b32 v170, s59
    v_mov_b32 v171, s59
    s_lshl_b32 s60, s3, 9
    v_lshl_add_u32 v11, v3, 4, s60
    v_mfma_f32_16x16x32_bf16 v[136:139], v[72:75], v[168:171], 0
    v_mfma_f32_16x16x32_bf16 v[140:143], v[76:79], v[168:171], 0
    v_mfma_f32_16x16x32_bf16 v[144:147], v[80:83], v[168:171], 0
    v_mfma_f32_16x16x32_bf16 v[148:151], v[84:87], v[168:171], 0
    v_mfma_f32_16x16x32_bf16 v[152:155], v[88:91], v[168:171], 0
    v_mfma_f32_16x16x32_bf16 v[156:159], v[92:95], v[168:171], 0
    v_mfma_f32_16x16x32_bf16 v[160:163], v[96:99], v[168:171], 0
    v_mfma_f32_16x16x32_bf16 v[164:167], v[100:103], v[168:171], 0
    v_mfma_f32_16x16x32_bf16 v[136:139], v[40:43], v[168:171], v[136:139]
    v_mfma_f32_16x16x32_bf16 v[140:143], v[44:47], v[168:171], v[140:143]
    v_mfma_f32_16x16x32_bf16 v[144:147], v[48:51], v[168:171], v[144:147]
    v_mfma_f32_16x16x32_bf16 v[148:151], v[52:55], v[168:171], v[148:151]
    v_mfma_f32_16x16x32_bf16 v[152:155], v[56:59], v[168:171], v[152:155]
    v_mfma_f32_16x16x32_bf16 v[156:159], v[60:63], v[168:171], v[156:159]
    v_mfma_f32_16x16x32_bf16 v[160:163], v[64:67], v[168:171], v[160:163]
    v_mfma_f32_16x16x32_bf16 v[164:167], v[68:71], v[168:171], v[164:167]
    s_lshl_b32 s60, s52, 12
    s_lshl_b32 s62, s61, 11
    s_add_u32 s60, s60, s62
    s_add_u32 s72, s60, 851968
    s_lshl_b32 s64, s64, 1
    s_add_u32 s64, s64, s63
    s_lshl_b32 s64, s64, 3
    s_add_u32 s64, s64, s52
    s_lshl_b32 s60, s64, 9
    s_add_u32 s73, s60, 720896
    s_mul_i32 s60, s64, 2176
    s_add_u32 s76, s60, 2623488
    s_lshl_b32 s62, s61, 10
    s_add_u32 s60, s60, s62
    s_add_u32 s74, s60, 2621440
    s_mul_i32 s60, s63, 4992
    s_lshl_b32 s62, s61, 8
    s_add_u32 s75, s60, s62
    s_lshl_b32 s70, s63, 9
    v_and_b32 v12, 31, v1
    v_lshlrev_b32 v12, 4, v12
    v_add_u32 v13, s70, v12
    v_and_b32 v14, 24, v1
    v_lshlrev_b32 v14, 1, v14
    v_and_b32 v9, 32, v1
    v_lshl_add_u32 v14, v9, 2, v14
    v_mul_u32_u24 v9, 624, v10
    v_add3_u32 v9, v9, v14, s75
    v_lshlrev_b32 v14, 4, v1
    s_lshl_b32 s60, s3, 6
    v_lshlrev_b32 v18, 3, v10
    v_add_u32 v18, s60, v18
    s_mov_b32 exec_lo, 0x10001
    s_mov_b32 exec_hi, 0x10001
    ds_write_b128 v11, v[136:139] offset:4608
    ds_write_b128 v11, v[140:143] offset:4672
    ds_write_b128 v11, v[144:147] offset:4736
    ds_write_b128 v11, v[148:151] offset:4800
    ds_write_b128 v11, v[152:155] offset:4864
    ds_write_b128 v11, v[156:159] offset:4928
    ds_write_b128 v11, v[160:163] offset:4992
    ds_write_b128 v11, v[164:167] offset:5056
    s_mov_b64 exec, -1
    s_waitcnt lgkmcnt(0)
    s_barrier
    s_cmp_ge_u32 s3, 2
    s_cbranch_scc1 L_nocs
    ds_read_b128 v[136:139], v13 offset:4608
    ds_read_b128 v[140:143], v13 offset:5632
    s_waitcnt lgkmcnt(0)
    v_pk_add_f32 v[136:137], v[136:137], v[140:141]
    v_pk_add_f32 v[138:139], v[138:139], v[142:143]
    v_add_u32 v136, 0x80, v136
    v_add_u32 v137, 0x80, v137
    v_add_u32 v138, 0x80, v138
    v_add_u32 v139, 0x80, v139
    v_bfi_b32 v136, v6, s48, v136
    v_bfi_b32 v137, v6, s49, v137
    v_bfi_b32 v138, v6, s50, v138
    v_bfi_b32 v139, v6, s51, v139
    s_mov_b32 exec_hi, 0
    buffer_store_dwordx4 v[136:139], v12, s[28:31], s73 offen offset:0 sc1
    s_mov_b64 exec, -1
L_nocs:
    v_mov_b32 v192, 0
    v_mov_b32 v193, 0
    s_mov_b32 s56, 0
L_poll_27:
    buffer_load_dwordx4 v[168:171], v8, s[28:31], s72 offen offset:0 sc1
    buffer_load_dwordx4 v[172:175], v8, s[28:31], s72 offen offset:1024 sc1
L_pollc_29:
    v_mov_b32 v16, 0
    s_waitcnt vmcnt(1)
    v_bitop3_b32 v16, v16, v168, s48 bitop3:0xf6
    v_bitop3_b32 v16, v16, v169, s49 bitop3:0xf6
    v_bitop3_b32 v16, v16, v170, s50 bitop3:0xf6
    v_bitop3_b32 v16, v16, v171, s51 bitop3:0xf6
    s_waitcnt vmcnt(0)
    v_bitop3_b32 v16, v16, v172, s48 bitop3:0xf6
    v_bitop3_b32 v16, v16, v173, s49 bitop3:0xf6
    v_bitop3_b32 v16, v16, v174, s50 bitop3:0xf6
    v_bitop3_b32 v16, v16, v175, s51 bitop3:0xf6
    v_and_b32 v16, 0xff, v16
    v_cmp_ne_u32 vcc, 0, v16
    s_cbranch_vccz L_polld_28
    s_add_u32 s56, s56, 1

    s_cmp_lt_u32 s56, 400
    s_cbranch_scc1 L_poll_27
    buffer_wbl2 sc1
    s_waitcnt vmcnt(0)
    buffer_inv sc1
    s_waitcnt vmcnt(0)

    s_cmp_lt_u32 s56, 60400
    s_cbranch_scc1 L_poll_27
L_polld_28:
    v_perm_b32 v184, v169, v168, s55
    v_perm_b32 v185, v171, v170, s55
    v_perm_b32 v188, v173, v172, s55
    v_perm_b32 v189, v175, v174, s55
    v_mov_b32_dpp v186, v184 row_ror:8 row_mask:0xf bank_mask:0xf
    v_mov_b32_dpp v187, v185 row_ror:8 row_mask:0xf bank_mask:0xf
    v_mov_b32_dpp v190, v188 row_ror:8 row_mask:0xf bank_mask:0xf
    v_mov_b32_dpp v191, v189 row_ror:8 row_mask:0xf bank_mask:0xf
    v_mfma_f32_16x16x32_bf16 v[136:139], v[72:75], v[184:187], 0
    v_dot2_f32_bf16 v192, v184, s59, v192
    v_dot2_f32_bf16 v193, v184, v184, v193
    v_mfma_f32_16x16x32_bf16 v[140:143], v[76:79], v[184:187], 0
    v_dot2_f32_bf16 v192, v185, s59, v192
    v_dot2_f32_bf16 v193, v185, v185, v193
    v_mfma_f32_16x16x32_bf16 v[144:147], v[80:83], v[184:187], 0
    v_dot2_f32_bf16 v192, v186, s59, v192
    v_dot2_f32_bf16 v193, v186, v186, v193
    v_mfma_f32_16x16x32_bf16 v[148:151], v[84:87], v[184:187], 0
    v_dot2_f32_bf16 v192, v187, s59, v192
    v_dot2_f32_bf16 v193, v187, v187, v193
    v_mfma_f32_16x16x32_bf16 v[152:155], v[88:91], v[184:187], 0
    v_dot2_f32_bf16 v192, v188, s59, v192
    v_dot2_f32_bf16 v193, v188, v188, v193
    v_mfma_f32_16x16x32_bf16 v[156:159], v[92:95], v[184:187], 0
    v_dot2_f32_bf16 v192, v189, s59, v192
    v_dot2_f32_bf16 v193, v189, v189, v193
    v_mfma_f32_16x16x32_bf16 v[160:163], v[96:99], v[184:187], 0
    v_dot2_f32_bf16 v192, v190, s59, v192
    v_dot2_f32_bf16 v193, v190, v190, v193
    v_mfma_f32_16x16x32_bf16 v[164:167], v[100:103], v[184:187], 0
    v_dot2_f32_bf16 v192, v191, s59, v192
    v_dot2_f32_bf16 v193, v191, v191, v193
    v_mfma_f32_16x16x32_bf16 v[136:139], v[40:43], v[188:191], v[136:139]
    s_nop 0
    v_mfma_f32_16x16x32_bf16 v[140:143], v[44:47], v[188:191], v[140:143]
    v_mov_b32 v194, v192
    v_mov_b32 v195, v193
    v_mfma_f32_16x16x32_bf16 v[144:147], v[48:51], v[188:191], v[144:147]
    v_permlane16_swap_b32 v192, v194
    v_permlane16_swap_b32 v193, v195
    v_mfma_f32_16x16x32_bf16 v[148:151], v[52:55], v[188:191], v[148:151]
    v_add_f32 v192, v192, v194
    v_add_f32 v193, v193, v195
    v_mfma_f32_16x16x32_bf16 v[152:155], v[56:59], v[188:191], v[152:155]
    v_mov_b32 v194, v192
    v_mov_b32 v195, v193
    v_mfma_f32_16x16x32_bf16 v[156:159], v[60:63], v[188:191], v[156:159]
    v_permlane32_swap_b32 v192, v194
    v_permlane32_swap_b32 v193, v195
    v_mfma_f32_16x16x32_bf16 v[160:163], v[64:67], v[188:191], v[160:163]
    v_add_f32 v192, v192, v194
    v_add_f32 v193, v193, v195
    v_mfma_f32_16x16x32_bf16 v[164:167], v[68:71], v[188:191], v[164:167]
    ds_write_b64 v18, v[192:193] offset:24448
    s_nop 0
    s_mov_b32 exec_lo, 0xff00ff
    s_mov_b32 exec_hi, 0xff00ff
    ds_write_b128 v7, v[136:139] offset:44672
    ds_write_b128 v7, v[140:143] offset:44736
    ds_write_b128 v7, v[144:147] offset:44800
    ds_write_b128 v7, v[148:151] offset:44864
    ds_write_b128 v7, v[152:155] offset:44928
    ds_write_b128 v7, v[156:159] offset:44992
    ds_write_b128 v7, v[160:163] offset:45056
    ds_write_b128 v7, v[164:167] offset:45120
    s_mov_b64 exec, -1
    s_waitcnt lgkmcnt(0)
    s_barrier
    ds_read_b128 v[136:139], v9 offset:44672
    ds_read_b128 v[140:143], v9 offset:54656
    ds_read_b128 v[144:147], v9 offset:44736
    ds_read_b128 v[148:151], v9 offset:54720
    ds_read_b64 v[194:195], v18 offset:24576
    s_waitcnt lgkmcnt(3)
    v_pk_add_f32 v[136:137], v[136:137], v[140:141]
    v_pk_add_f32 v[138:139], v[138:139], v[142:143]
    v_cvt_pk_bf16_f32 v152, v136, v137
    v_cvt_pk_bf16_f32 v153, v138, v139
    s_waitcnt lgkmcnt(1)
    v_pk_add_f32 v[144:145], v[144:145], v[148:149]
    v_pk_add_f32 v[146:147], v[146:147], v[150:151]
    v_cvt_pk_bf16_f32 v154, v144, v145
    v_cvt_pk_bf16_f32 v155, v146, v147
    v_min_u32 v155, 0xfffffffe, v155
    buffer_store_dwordx4 v[152:155], v14, s[28:31], s74 offen offset:0 sc1
    s_cmp_ge_u32 s3, 2
    s_cbranch_scc1 L_nost
    s_waitcnt lgkmcnt(0)
    v_pk_add_f32 v[192:193], v[192:193], v[194:195]
    v_add_u32 v192, 0x80, v192
    v_add_u32 v193, 0x80, v193
    v_add_u32 v194, 0x80, v194
    v_add_u32 v195, 0x80, v195
    v_bfi_b32 v192, v6, s48, v192
    v_bfi_b32 v193, v6, s49, v193
    v_bfi_b32 v194, v6, s50, v194
    v_bfi_b32 v195, v6, s51, v195
    s_mov_b64 exec, 0xff
    buffer_store_dwordx4 v[192:195], v14, s[28:31], s76 offen offset:0 sc1
    s_mov_b64 exec, -1
L_nost:
L_Bend:
    s_endpgm
L_A:
    s_and_b32 s3, s3, 3
    v_lshlrev_b32 v7, 2, v1
    ds_write_b32 v7, v4
    s_and_b32 s60, s52, 1
    s_lshl_b32 s60, s60, 2
    s_lshr_b32 s61, s53, 3
    s_add_u32 s60, s60, s61
    s_lshr_b32 s61, s52, 1
    s_lshl_b32 s62, s60, 2
    s_add_u32 s62, s62, s61
    s_lshl_b32 s62, s62, 20
    s_and_b32 s63, s53, 7
    s_lshl_b32 s63, s63, 15
    s_add_u32 s62, s62, s63
    s_lshl_b32 s63, s3, 13
    s_add_u32 s62, s62, s63
    s_add_u32 s68, s62, 786432
    s_add_u32 s69, s68, 4096
    v_lshlrev_b32 v17, 8, v2
    v_lshl_or_b32 v17, v3, 4, v17
    v_lshrrev_b32 v8, 3, v1
    v_xor_b32 v17, v8, v1
    v_and_b32 v17, 7, v17
    v_lshlrev_b32 v17, 4, v17
    v_lshl_or_b32 v17, v8, 8, v17
    s_mul_i32 s64, s3, 8192
    s_add_u32 s59, s64, 64640
    v_and_b32 v8, 7, v2
    v_xor_b32 v235, v8, v3
    v_lshlrev_b32 v235, 4, v235
    v_lshl_or_b32 v235, v8, 7, v235
    v_lshrrev_b32 v8, 3, v2
    v_lshl_or_b32 v235, v8, 11, v235
    v_add_u32 v235, s59, v235
    v_lshlrev_b32 v18, 10, v3
    v_lshl_or_b32 v18, v2, 4, v18
    s_waitcnt lgkmcnt(0)
    s_mov_b32 s36, s6
    s_mov_b32 s37, s7
    s_mov_b32 s38, 0x2000000
    s_mov_b32 s39, 0x20000
    s_mov_b32 s40, s8
    s_mov_b32 s41, s9
    s_mov_b32 s42, 0x2000000
    s_mov_b32 s43, 0x20000
    s_barrier
    s_mov_b32 s28, s24
    s_mov_b32 s29, s25
    s_mov_b32 s30, 0x10000000
    s_mov_b32 s31, 0x20000
    s_mov_b32 s32, s24
    s_mov_b32 s33, s25
    s_mov_b32 s34, 0x2000000
    s_mov_b32 s35, 0x20000
    s_add_u32 s44, s24, 0x1000000
    s_addc_u32 s45, s25, 0
    s_mov_b32 s46, 0x2000000
    s_mov_b32 s47, 0x20000
    s_lshl_b32 s61, s2, 9
    s_lshl_b32 s60, s3, 7
    s_add_u32 s61, s61, s60
    s_add_u32 s70, s61, 2490368
    s_lshl_b32 s60, s2, 12
    s_add_u32 s71, s60, 1441792
    v_lshlrev_b32 v19, 4, v0
    v_and_b32 v7, 7, v2
    v_mul_u32_u24 v12, 272, v7
    v_lshl_add_u32 v12, v3, 4, v12
    v_mul_u32_u24 v7, 624, v7
    v_lshl_add_u32 v7, v3, 4, v7
    s_mul_i32 s60, s3, 4992
    v_add_u32 v7, s60, v7
    v_lshl_add_u32 v13, v3, 4, v7
    v_lshrrev_b32 v11, 5, v0
    v_mul_u32_u24 v8, 624, v11
    v_lshlrev_b32 v11, 4, v11
    v_and_b32 v9, 31, v0
    v_lshl_add_u32 v8, v9, 4, v8
    v_lshlrev_b32 v9, 4, v2
    s_lshl_b32 s60, s3, 2
    v_add_u32 v10, s60, v9
    s_getreg_b32 s64, hwreg(HW_REG_XCC_ID, 0, 4)
    s_lshl_b32 s64, s64, 8
    s_mov_b32 s65, 0x3db504f3
    s_mov_b32 s66, 0x3fb8aa3b
    v_mov_b32 v184, s65
    v_mov_b32 v186, s66
    s_getpc_b64 s[60:61]
    L_pc:
    s_sub_u32 s60, s60, L_pc-sequential_preLN__sliding_block_cached__dense_activation_relu__decode_kernel
    s_subb_u32 s61, s61, 0
    v_lshlrev_b32 v172, 7, v0
    v_cmp_gt_u32 vcc, L_end-sequential_preLN__sliding_block_cached__dense_activation_relu__decode_kernel, v172
    s_and_saveexec_b64 s[62:63], vcc
    s_cbranch_execz L_cpf
    global_load_dword v173, v172, s[60:61]
    L_cpf:
    s_mov_b64 exec, -1

L_lw_30:
    s_sleep 1
    ds_read_b32 v15, v4 offset:16
    s_waitcnt lgkmcnt(0)
    v_readfirstlane_b32 s67, v15
    s_cmp_lt_u32 s67, 1
    s_cbranch_scc1 L_lw_30

    s_load_dword s58, s[24:25], 0
    s_add_u32 m0, s59, 0
    s_nop 0
    buffer_load_dwordx4 v17, s[36:39], s68 offen offset:0 nt lds
    s_add_u32 m0, s59, 896
    s_nop 0
    buffer_load_dwordx4 v17, s[36:39], s68 offen offset:128 nt lds
    s_add_u32 m0, s59, 0
    s_nop 0
    buffer_load_dwordx4 v17, s[36:39], s68 offen offset:2048 nt lds
    s_add_u32 m0, s59, 896
    s_nop 0
    buffer_load_dwordx4 v17, s[36:39], s68 offen offset:2176 nt lds
    s_add_u32 m0, s59, 4096
    s_nop 0
    buffer_load_dwordx4 v17, s[36:39], s69 offen offset:0 nt lds
L_lw_31:
    s_sleep 1
    ds_read_b32 v15, v4 offset:48
    s_waitcnt lgkmcnt(0)
    v_readfirstlane_b32 s67, v15
    s_cmp_lt_u32 s67, 4
    s_cbranch_scc1 L_lw_31

    s_add_u32 m0, s59, 4992
    s_nop 0
    buffer_load_dwordx4 v17, s[36:39], s69 offen offset:128 nt lds
    s_add_u32 m0, s59, 4096
    s_nop 0
    buffer_load_dwordx4 v17, s[36:39], s69 offen offset:2048 nt lds
    s_add_u32 m0, s59, 4992
    s_nop 0
    buffer_load_dwordx4 v17, s[36:39], s69 offen offset:2176 nt lds
    buffer_load_dwordx4 v[52:55], v18, s[40:43], s68 offen offset:0 nt
    buffer_load_dwordx4 v[56:59], v18, s[40:43], s68 offen offset:256 nt
    buffer_load_dwordx4 v[60:63], v18, s[40:43], s68 offen offset:512 nt
    buffer_load_dwordx4 v[64:67], v18, s[40:43], s68 offen offset:768 nt
    s_waitcnt vmcnt(7)
    s_mov_b64 exec, 1
    ds_add_u32 v4, v5 offset:52
    s_mov_b64 exec, -1
L_lw_32:
    s_sleep 1
    ds_read_b32 v15, v4 offset:44
    s_waitcnt lgkmcnt(0)
    v_readfirstlane_b32 s67, v15
    s_cmp_lt_u32 s67, 4
    s_cbranch_scc1 L_lw_32

    buffer_load_dwordx4 v[68:71], v18, s[40:43], s69 offen offset:0 nt
    buffer_load_dwordx4 v[72:75], v18, s[40:43], s69 offen offset:256 nt
    buffer_load_dwordx4 v[76:79], v18, s[40:43], s69 offen offset:512 nt
    buffer_load_dwordx4 v[80:83], v18, s[40:43], s69 offen offset:768 nt
    s_mov_b64 exec, 1
    ds_add_u32 v4, v5 offset:32
    s_mov_b64 exec, -1
    s_waitcnt lgkmcnt(0)
    s_add_u32 s48, s58, 1
    s_add_u32 s96, s58, 2
    s_lshr_b32 s49, s48, 8
    s_lshr_b32 s50, s48, 16
    s_lshr_b32 s51, s48, 24
    s_lshr_b32 s97, s96, 8
    s_lshr_b32 s98, s96, 16
    s_lshr_b32 s99, s96, 24
    s_waitcnt vmcnt(8)
    v_xor_b32 v15, 64, v235
    ds_read_b128 v[20:23], v235 offset:0
    ds_read_b128 v[24:27], v15 offset:0
    ds_read_b128 v[28:31], v235 offset:1024
    ds_read_b128 v[32:35], v15 offset:1024
    ds_read_b128 v[36:39], v235 offset:4096
    ds_read_b128 v[40:43], v15 offset:4096
    ds_read_b128 v[44:47], v235 offset:5120
    ds_read_b128 v[48:51], v15 offset:5120
    s_waitcnt lgkmcnt(0)
L_lw_33:
    ds_read_b32 v15, v4 offset:8
    ds_read_b128 v[148:151], v12 offset:22016
    ds_read_b128 v[152:155], v12 offset:22080
    ds_read_b128 v[156:159], v12 offset:22144
    ds_read_b128 v[160:163], v12 offset:22208
    s_waitcnt lgkmcnt(0)
    v_readfirstlane_b32 s67, v15
    s_cmp_lt_u32 s67, 4
    s_cbranch_scc1 L_lw_33

    s_waitcnt vmcnt(8)
    v_mfma_f32_16x16x32_bf16 v[164:167], v[20:23], v[148:151], 0
    v_mfma_f32_16x16x32_bf16 v[168:171], v[36:39], v[148:151], 0
    v_mfma_f32_16x16x32_bf16 v[164:167], v[24:27], v[152:155], v[164:167]
    v_mfma_f32_16x16x32_bf16 v[168:171], v[40:43], v[152:155], v[168:171]
    v_mfma_f32_16x16x32_bf16 v[164:167], v[28:31], v[156:159], v[164:167]
    v_mfma_f32_16x16x32_bf16 v[168:171], v[44:47], v[156:159], v[168:171]
    v_mfma_f32_16x16x32_bf16 v[164:167], v[32:35], v[160:163], v[164:167]
    v_mfma_f32_16x16x32_bf16 v[168:171], v[48:51], v[160:163], v[168:171]
    s_nop 6
    v_cvt_pk_bf16_f32 v172, v164, v165
    v_cvt_pk_bf16_f32 v173, v166, v167
    v_cvt_pk_bf16_f32 v174, v168, v169
    v_cvt_pk_bf16_f32 v175, v170, v171
    v_lshlrev_b32 v164, 16, v172
    v_and_b32 v165, 0xffff0000, v172
    v_lshlrev_b32 v166, 16, v173
    v_and_b32 v167, 0xffff0000, v173
    v_lshlrev_b32 v168, 16, v174
    v_and_b32 v169, 0xffff0000, v174
    v_lshlrev_b32 v170, 16, v175
    v_and_b32 v171, 0xffff0000, v175
    v_pk_mul_f32 v[164:165], v[164:165], v[184:185] op_sel_hi:[1,0]
    v_pk_mul_f32 v[166:167], v[166:167], v[184:185] op_sel_hi:[1,0]
    v_pk_mul_f32 v[168:169], v[168:169], v[184:185] op_sel_hi:[1,0]
    v_pk_mul_f32 v[170:171], v[170:171], v[184:185] op_sel_hi:[1,0]
    v_cvt_pk_bf16_f32 v172, v164, v165
    v_cvt_pk_bf16_f32 v173, v166, v167
    v_cvt_pk_bf16_f32 v174, v168, v169
    v_cvt_pk_bf16_f32 v175, v170, v171
    v_lshlrev_b32 v164, 16, v172
    v_and_b32 v165, 0xffff0000, v172
    v_lshlrev_b32 v166, 16, v173
    v_and_b32 v167, 0xffff0000, v173
    v_lshlrev_b32 v168, 16, v174
    v_and_b32 v169, 0xffff0000, v174
    v_lshlrev_b32 v170, 16, v175
    v_and_b32 v171, 0xffff0000, v175
    v_max3_f32 v176, v164, v165, v166
    v_max3_f32 v172, v167, v168, v169
    v_max3_f32 v176, v176, v170, v171
    v_max_f32 v176, v176, v172
    v_mov_b32 v172, v176
    s_nop 1
    v_permlane16_swap_b32 v176, v172
    v_max_f32 v176, v176, v172
    v_mov_b32 v172, v176
    s_nop 1
    v_permlane32_swap_b32 v176, v172
    v_max_f32 v176, v176, v172
    v_mul_f32 v174, s66, v176
    ds_write_b32 v10, v176 offset:24192
    v_pk_fma_f32 v[164:165], v[164:165], v[186:187], v[174:175] op_sel_hi:[1,0,0] neg_lo:[0,0,1] neg_hi:[0,0,1]
    v_pk_fma_f32 v[166:167], v[166:167], v[186:187], v[174:175] op_sel_hi:[1,0,0] neg_lo:[0,0,1] neg_hi:[0,0,1]
    v_pk_fma_f32 v[168:169], v[168:169], v[186:187], v[174:175] op_sel_hi:[1,0,0] neg_lo:[0,0,1] neg_hi:[0,0,1]
    v_pk_fma_f32 v[170:171], v[170:171], v[186:187], v[174:175] op_sel_hi:[1,0,0] neg_lo:[0,0,1] neg_hi:[0,0,1]
    v_exp_f32 v164, v164
    v_exp_f32 v165, v165
    v_exp_f32 v166, v166
    v_exp_f32 v167, v167
    v_exp_f32 v168, v168
    v_exp_f32 v169, v169
    v_exp_f32 v170, v170
    v_exp_f32 v171, v171
    s_nop 0
    v_cvt_pk_bf16_f32 v180, v164, v165
    v_cvt_pk_bf16_f32 v181, v166, v167
    v_cvt_pk_bf16_f32 v182, v168, v169
    v_cvt_pk_bf16_f32 v183, v170, v171
    s_waitcnt vmcnt(6)
    v_perm_b32 v84, v56, v52, s54
    v_perm_b32 v88, v56, v52, s55
    v_perm_b32 v92, v57, v53, s54
    v_perm_b32 v96, v57, v53, s55
    v_perm_b32 v100, v58, v54, s54
    v_perm_b32 v104, v58, v54, s55
    v_perm_b32 v108, v59, v55, s54
    v_perm_b32 v112, v59, v55, s55
    s_waitcnt vmcnt(4)
    v_perm_b32 v85, v64, v60, s54
    v_perm_b32 v89, v64, v60, s55
    v_perm_b32 v93, v65, v61, s54
    v_perm_b32 v97, v65, v61, s55
    v_perm_b32 v101, v66, v62, s54
    v_perm_b32 v105, v66, v62, s55
    v_perm_b32 v109, v67, v63, s54
    v_perm_b32 v113, v67, v63, s55
    s_waitcnt vmcnt(2)
    v_perm_b32 v86, v72, v68, s54
    v_perm_b32 v90, v72, v68, s55
    v_perm_b32 v94, v73, v69, s54
    v_perm_b32 v98, v73, v69, s55
    v_perm_b32 v102, v74, v70, s54
    v_perm_b32 v106, v74, v70, s55
    v_perm_b32 v110, v75, v71, s54
    v_perm_b32 v114, v75, v71, s55
    s_waitcnt vmcnt(0)
    v_perm_b32 v87, v80, v76, s54
    v_perm_b32 v91, v80, v76, s55
    v_perm_b32 v95, v81, v77, s54
    v_perm_b32 v99, v81, v77, s55
    v_perm_b32 v103, v82, v78, s54
    v_perm_b32 v107, v82, v78, s55
    v_perm_b32 v111, v83, v79, s54
    v_perm_b32 v115, v83, v79, s55
    v_add_f32 v177, v164, v165
    v_add_f32 v172, v166, v167
    v_mfma_f32_16x16x32_bf16 v[200:203], v[84:87], v[180:183], 0
    v_add_f32 v173, v168, v169
    v_add_f32 v174, v170, v171
    v_mfma_f32_16x16x32_bf16 v[204:207], v[88:91], v[180:183], 0
    v_add_f32 v177, v177, v172
    v_add_f32 v173, v173, v174
    v_mfma_f32_16x16x32_bf16 v[208:211], v[92:95], v[180:183], 0
    v_add_f32 v177, v177, v173
    v_mov_b32 v174, s64
    v_mfma_f32_16x16x32_bf16 v[212:215], v[96:99], v[180:183], 0
    v_mov_b32 v172, v177
    v_mov_b32 v175, 0
    v_mfma_f32_16x16x32_bf16 v[216:219], v[100:103], v[180:183], 0
    v_permlane16_swap_b32 v177, v172
    v_add_f32 v177, v177, v172
    v_mfma_f32_16x16x32_bf16 v[220:223], v[104:107], v[180:183], 0
    v_mov_b32 v172, v177
    s_nop 0
    v_mfma_f32_16x16x32_bf16 v[224:227], v[108:111], v[180:183], 0
    v_permlane32_swap_b32 v177, v172
    v_add_f32 v173, v177, v172
    v_mfma_f32_16x16x32_bf16 v[228:231], v[112:115], v[180:183], 0
    v_mov_b32 v172, v176
    v_add_u32 v173, 0x80, v173
    v_bfi_b32 v172, v6, s48, v172
    v_bfi_b32 v173, v6, s49, v173
    v_bfi_b32 v174, v6, s50, v174
    v_bfi_b32 v175, v6, s51, v175
    s_mov_b64 exec, 0xff
    buffer_store_dwordx4 v[172:175], v9, s[28:31], s70 offen offset:0
    s_mov_b32 exec_lo, 0xff00ff
    s_mov_b32 exec_hi, 0xff00ff
    ds_write_b128 v13, v[200:203] offset:24704
    ds_write_b128 v13, v[204:207] offset:24720
    ds_write_b128 v13, v[208:211] offset:24832
    ds_write_b128 v13, v[212:215] offset:24848
    ds_write_b128 v13, v[216:219] offset:24960
    ds_write_b128 v13, v[220:223] offset:24976
    ds_write_b128 v13, v[224:227] offset:25088
    ds_write_b128 v13, v[228:231] offset:25104
    s_mov_b64 exec, -1
    s_mov_b64 exec, 1
    ds_add_rtn_u32 v15, v4, v5 offset:12
    s_waitcnt lgkmcnt(0)
    v_readfirstlane_b32 s67, v15
    s_cmp_eq_u32 s67, 3
    s_cbranch_scc1 L_bard_35

L_bar_34:
    ds_read_b32 v15, v4 offset:12
    s_waitcnt lgkmcnt(0)
    v_readfirstlane_b32 s67, v15
    s_cmp_lt_u32 s67, 4
    s_cbranch_scc1 L_bar_34

L_bard_35:
    s_mov_b64 exec, -1
    ds_read_b128 v[172:175], v11 offset:24192
    ds_read_b128 v[200:203], v8 offset:24704
    ds_read_b128 v[204:207], v8 offset:29696
    ds_read_b128 v[208:211], v8 offset:34688
    ds_read_b128 v[212:215], v8 offset:39680
    s_waitcnt lgkmcnt(4)
    v_max3_f32 v176, v172, v173, v174
    v_max_f32 v176, v176, v175
    v_sub_f32 v172, v172, v176
    v_sub_f32 v173, v173, v176
    v_sub_f32 v174, v174, v176
    v_sub_f32 v175, v175, v176
    v_mul_f32 v172, s66, v172
    v_mul_f32 v173, s66, v173
    v_mul_f32 v174, s66, v174
    v_mul_f32 v175, s66, v175
    v_exp_f32 v172, v172
    v_exp_f32 v173, v173
    v_exp_f32 v174, v174
    v_exp_f32 v175, v175
    s_waitcnt lgkmcnt(3)
    v_mul_f32 v200, v200, v172
    v_mul_f32 v201, v201, v172
    v_mul_f32 v202, v202, v172
    v_mul_f32 v203, v203, v172
    s_waitcnt lgkmcnt(2)
    v_fmac_f32 v200, v204, v173
    v_fmac_f32 v201, v205, v173
    v_fmac_f32 v202, v206, v173
    v_fmac_f32 v203, v207, v173
    s_waitcnt lgkmcnt(1)
    v_fmac_f32 v200, v208, v174
    v_fmac_f32 v201, v209, v174
    v_fmac_f32 v202, v210, v174
    v_fmac_f32 v203, v211, v174
    s_waitcnt lgkmcnt(0)
    v_fmac_f32 v200, v212, v175
    v_fmac_f32 v201, v213, v175
    v_fmac_f32 v202, v214, v175
    v_fmac_f32 v203, v215, v175
    v_add_u32 v200, 0x80, v200
    v_add_u32 v201, 0x80, v201
    v_add_u32 v202, 0x80, v202
    v_add_u32 v203, 0x80, v203
    v_bfi_b32 v200, v6, s48, v200
    v_bfi_b32 v201, v6, s49, v201
    v_bfi_b32 v202, v6, s50, v202
    v_bfi_b32 v203, v6, s51, v203
    buffer_store_dwordx4 v[200:203], v19, s[28:31], s71 offen offset:0
    s_mov_b64 exec, 1
    ds_add_u32 v4, v5 offset:20
    s_mov_b64 exec, -1
    v_and_b32 v9, 31, v1
    v_lshrrev_b32 v10, 5, v1
    v_lshlrev_b32 v156, 4, v10
    v_lshl_add_u32 v157, v9, 15, v156
    v_lshlrev_b32 v158, 11, v10
    s_lshl_b32 s61, s53, 7
    s_lshl_b32 s60, s3, 5
    s_add_u32 s61, s61, s60
    s_lshl_b32 s60, s52, 12
    s_add_u32 s60, s60, s61
    s_add_u32 s26, s60, 851968
    s_add_u32 s27, s60, 1441792
    s_lshl_b32 s60, s3, 12
    s_lshl_b32 s61, s52, 8
    s_add_u32 s60, s60, s61
    s_and_b32 s61, s53, 3
    s_lshl_b32 s61, s61, 6
    s_add_u32 s60, s60, s61
    s_lshr_b32 s61, s53, 2
    s_lshl_b32 s61, s61, 1
    s_add_u32 s79, s60, s61
    v_and_b32 v8, 7, v0
    v_mul_u32_u24 v8, 624, v8
    v_lshrrev_b32 v9, 3, v0
    v_lshl_add_u32 v8, v9, 4, v8
    s_cmp_lt_u32 s53, 28
    s_cbranch_scc1 L_w2
    s_cmp_ge_u32 s53, 30
    s_cbranch_scc1 L_idle
    s_barrier
    s_barrier
L_idle:
    s_mov_b32 s56, 0
L_gate_36:
    buffer_load_dwordx4 v[152:155], v156, s[28:31], s26 offen offset:0 sc1
    v_mov_b32 v16, 0
    s_waitcnt vmcnt(0)
    v_bitop3_b32 v16, v16, v152, s48 bitop3:0xf6
    v_bitop3_b32 v16, v16, v153, s49 bitop3:0xf6
    v_bitop3_b32 v16, v16, v154, s50 bitop3:0xf6
    v_bitop3_b32 v16, v16, v155, s51 bitop3:0xf6
    v_and_b32 v16, 0xff, v16
    v_cmp_ne_u32 vcc, 0, v16
    s_cbranch_vccz L_gated_37
    s_add_u32 s56, s56, 1
    s_sleep 16
    s_cmp_lt_u32 s56, 400
    s_cbranch_scc1 L_gate_36
    buffer_wbl2 sc1
    s_waitcnt vmcnt(0)
    buffer_inv sc1
    s_waitcnt vmcnt(0)
    s_cmp_lt_u32 s56, 60400
    s_cbranch_scc1 L_gate_36

L_gated_37:
    s_branch L_final
L_w2:
    s_mov_b32 s36, s18
    s_mov_b32 s37, s19
    s_mov_b32 s38, 0x700000
    s_mov_b32 s39, 0x20000
    s_lshl_b32 s60, s53, 18
    s_lshl_b32 s61, s3, 12
    s_add_u32 s60, s60, s61
    s_lshl_b32 s61, s52, 8
    s_add_u32 s68, s60, s61
    s_add_u32 s69, s68, 0x4000
    s_add_u32 s70, s68, 0x8000
    s_add_u32 s72, s68, 0xc000
    v_lshlrev_b32 v17, 16, v3
    v_lshl_or_b32 v17, v2, 4, v17
    v_lshrrev_b32 v9, 3, v2
    v_and_b32 v10, 7, v2
    s_lshl_b32 s60, s3, 7
    v_lshl_add_u32 v11, v3, 4, s60
    v_lshl_add_u32 v12, v9, 6, v11
    v_lshl_add_u32 v12, v10, 9, v12
    v_lshlrev_b32 v11, 7, v3
    s_lshl_b32 s60, s3, 9
    v_lshl_add_u32 v11, v10, 4, v11
    v_add_u32 v11, s60, v11
    v_mul_u32_u24 v9, 8704, v9
    v_add_u32 v11, v11, v9
    v_lshrrev_b32 v13, 3, v1
    v_mul_u32_u24 v13, 2176, v13
    v_lshl_add_u32 v13, v10, 4, v13
    s_lshl_b32 s60, s53, 12
    s_add_u32 s73, s60, 720896
    s_mul_i32 s60, s53, 17408
    s_add_u32 s74, s60, 2621440
    s_add_u32 s75, s74, 2176
    s_add_u32 s76, s74, 4352
    s_add_u32 s77, s74, 6528
    s_add_u32 s78, s74, 2048
    s_cmp_lt_u32 s53, 16
    s_cbranch_scc1 L_w2o
    s_cmp_lt_u32 s53, 24
    s_cbranch_scc1 L_w2p
L_lw_38:
    s_sleep 2
    ds_read_b32 v15, v4 offset:36
    s_waitcnt lgkmcnt(0)
    v_readfirstlane_b32 s67, v15
    s_cmp_lt_u32 s67, 4
    s_cbranch_scc1 L_lw_38

L_w2p:
    buffer_load_dwordx4 v[20:23], v17, s[36:39], s68 offen offset:0 nt
    buffer_load_dwordx4 v[24:27], v17, s[36:39], s69 offen offset:0 nt
    buffer_load_dwordx4 v[28:31], v17, s[36:39], s70 offen offset:0 nt
    buffer_load_dwordx4 v[32:35], v17, s[36:39], s72 offen offset:0 nt
    buffer_load_dwordx4 v[36:39], v17, s[36:39], s68 offen offset:2048 nt
    buffer_load_dwordx4 v[40:43], v17, s[36:39], s69 offen offset:2048 nt
    buffer_load_dwordx4 v[44:47], v17, s[36:39], s70 offen offset:2048 nt
    buffer_load_dwordx4 v[48:51], v17, s[36:39], s72 offen offset:2048 nt
    s_barrier
    s_barrier
    s_branch L_w2j
L_w2o:
    s_barrier
L_lw_39:
    s_sleep 1
    ds_read_b32 v15, v4 offset:24
    s_waitcnt lgkmcnt(0)
    v_readfirstlane_b32 s67, v15
    s_cmp_lt_u32 s67, 4
    s_cbranch_scc1 L_lw_39

    buffer_load_dwordx4 v[20:23], v17, s[36:39], s68 offen offset:0 nt
    buffer_load_dwordx4 v[24:27], v17, s[36:39], s69 offen offset:0 nt
    buffer_load_dwordx4 v[28:31], v17, s[36:39], s70 offen offset:0 nt
    buffer_load_dwordx4 v[32:35], v17, s[36:39], s72 offen offset:0 nt
    buffer_load_dwordx4 v[36:39], v17, s[36:39], s68 offen offset:2048 nt
    buffer_load_dwordx4 v[40:43], v17, s[36:39], s69 offen offset:2048 nt
    buffer_load_dwordx4 v[44:47], v17, s[36:39], s70 offen offset:2048 nt
    buffer_load_dwordx4 v[48:51], v17, s[36:39], s72 offen offset:2048 nt
L_w2j:
    v_and_b32 v14, 31, v1
    v_lshlrev_b32 v14, 12, v14
    s_lshl_b32 s60, s52, 9
    s_add_u32 s60, s60, 2490368
    buffer_load_dwordx4 v[160:163], v14, s[28:31], s60 offen offset:0 sc1
    buffer_load_dwordx4 v[120:123], v12, s[28:31], s73 offen offset:0 sc1
    buffer_load_dwordx4 v[152:155], v156, s[28:31], s26 offen offset:0 sc1
    s_waitcnt vmcnt(9)
    v_perm_b32 v52, v24, v20, s54
    v_perm_b32 v56, v24, v20, s55
    v_perm_b32 v60, v25, v21, s54
    v_perm_b32 v64, v25, v21, s55
    v_perm_b32 v68, v26, v22, s54
    v_perm_b32 v72, v26, v22, s55
    v_perm_b32 v76, v27, v23, s54
    v_perm_b32 v80, v27, v23, s55
    s_waitcnt vmcnt(7)
    v_perm_b32 v53, v32, v28, s54
    v_perm_b32 v57, v32, v28, s55
    v_perm_b32 v61, v33, v29, s54
    v_perm_b32 v65, v33, v29, s55
    v_perm_b32 v69, v34, v30, s54
    v_perm_b32 v73, v34, v30, s55
    v_perm_b32 v77, v35, v31, s54
    v_perm_b32 v81, v35, v31, s55
    s_waitcnt vmcnt(5)
    v_perm_b32 v54, v40, v36, s54
    v_perm_b32 v58, v40, v36, s55
    v_perm_b32 v62, v41, v37, s54
    v_perm_b32 v66, v41, v37, s55
    v_perm_b32 v70, v42, v38, s54
    v_perm_b32 v74, v42, v38, s55
    v_perm_b32 v78, v43, v39, s54
    v_perm_b32 v82, v43, v39, s55
    s_waitcnt vmcnt(3)
    v_perm_b32 v55, v48, v44, s54
    v_perm_b32 v59, v48, v44, s55
    v_perm_b32 v63, v49, v45, s54
    v_perm_b32 v67, v49, v45, s55
    v_perm_b32 v71, v50, v46, s54
    v_perm_b32 v75, v50, v46, s55
    v_perm_b32 v79, v51, v47, s54
    v_perm_b32 v83, v51, v47, s55
    v_mov_b32 v16, 0
    s_waitcnt vmcnt(2)
    v_bitop3_b32 v16, v16, v160, s48 bitop3:0xf6
    v_bitop3_b32 v16, v16, v161, s49 bitop3:0xf6
    v_bitop3_b32 v16, v16, v162, s50 bitop3:0xf6
    v_bitop3_b32 v16, v16, v163, s51 bitop3:0xf6
    v_and_b32 v16, 0xff, v16
    v_xor_b32 v162, s64, v162
    v_and_b32 v162, 0xf00, v162
    v_or_b32 v16, v16, v162
    v_cmp_ne_u32 vcc, 0, v16
    s_or_b32 s65, vcc_lo, vcc_hi
    s_mov_b32 s56, 0
    s_mov_b32 s57, 3
    s_branch L_gpc_42
L_gp_40:
    s_bitcmp1_b32 s57, 0
    s_cbranch_scc0 L_gs_43
    buffer_load_dwordx4 v[120:123], v12, s[28:31], s73 offen offset:0 sc1
L_gs_43:
    s_bitcmp1_b32 s57, 1
    s_cbranch_scc0 L_gs_44
    buffer_load_dwordx4 v[152:155], v156, s[28:31], s26 offen offset:0 sc1
L_gs_44:
L_gpc_42:
    s_waitcnt vmcnt(0)
    s_bitcmp1_b32 s57, 0
    s_cbranch_scc0 L_gc_45
    v_mov_b32 v16, 0
    v_bitop3_b32 v16, v16, v120, s48 bitop3:0xf6
    v_bitop3_b32 v16, v16, v121, s49 bitop3:0xf6
    v_bitop3_b32 v16, v16, v122, s50 bitop3:0xf6
    v_bitop3_b32 v16, v16, v123, s51 bitop3:0xf6
    v_and_b32 v16, 0xff, v16
    v_cmp_ne_u32 vcc, 0, v16
    s_cbranch_vccnz L_gc_45
    s_bitset0_b32 s57, 0
    v_and_b32 v120, 0xffffff00, v120
    v_and_b32 v121, 0xffffff00, v121
    v_and_b32 v122, 0xffffff00, v122
    v_and_b32 v123, 0xffffff00, v123
    s_nop 0
    v_add_f32_dpp v120, v120, v120 quad_perm:[1,0,3,2] row_mask:0xf bank_mask:0xf
    v_add_f32_dpp v121, v121, v121 quad_perm:[1,0,3,2] row_mask:0xf bank_mask:0xf
    v_add_f32_dpp v122, v122, v122 quad_perm:[1,0,3,2] row_mask:0xf bank_mask:0xf
    v_add_f32_dpp v123, v123, v123 quad_perm:[1,0,3,2] row_mask:0xf bank_mask:0xf
    v_add_f32_dpp v120, v120, v120 quad_perm:[2,3,0,1] row_mask:0xf bank_mask:0xf
    v_add_f32_dpp v121, v121, v121 quad_perm:[2,3,0,1] row_mask:0xf bank_mask:0xf
    v_add_f32_dpp v122, v122, v122 quad_perm:[2,3,0,1] row_mask:0xf bank_mask:0xf
    v_add_f32_dpp v123, v123, v123 quad_perm:[2,3,0,1] row_mask:0xf bank_mask:0xf
    v_add_f32_dpp v120, v120, v120 row_half_mirror row_mask:0xf bank_mask:0xf
    v_add_f32_dpp v121, v121, v121 row_half_mirror row_mask:0xf bank_mask:0xf
    v_add_f32_dpp v122, v122, v122 row_half_mirror row_mask:0xf bank_mask:0xf
    v_add_f32_dpp v123, v123, v123 row_half_mirror row_mask:0xf bank_mask:0xf
    v_mov_b32_dpp v124, v120 row_ror:8 row_mask:0xf bank_mask:0xf
    v_mov_b32_dpp v125, v121 row_ror:8 row_mask:0xf bank_mask:0xf
    v_mov_b32_dpp v126, v122 row_ror:8 row_mask:0xf bank_mask:0xf
    v_mov_b32_dpp v127, v123 row_ror:8 row_mask:0xf bank_mask:0xf
L_gc_45:
    s_bitcmp1_b32 s57, 1
    s_cbranch_scc0 L_gc_46
    v_mov_b32 v16, 0
    v_bitop3_b32 v16, v16, v152, s48 bitop3:0xf6
    v_bitop3_b32 v16, v16, v153, s49 bitop3:0xf6
    v_bitop3_b32 v16, v16, v154, s50 bitop3:0xf6
    v_bitop3_b32 v16, v16, v155, s51 bitop3:0xf6
    v_and_b32 v16, 0xff, v16
    v_cmp_ne_u32 vcc, 0, v16
    s_cbranch_vccnz L_gc_46
    s_bitset0_b32 s57, 1
L_gc_46:
    s_cmp_eq_u32 s57, 0
    s_cbranch_scc1 L_gpd_41
    s_add_u32 s56, s56, 1
    s_cmp_lt_u32 s56, 400
    s_cbranch_scc1 L_gp_40
    buffer_wbl2 sc1
    s_waitcnt vmcnt(0)
    buffer_inv sc1
    s_waitcnt vmcnt(0)
    s_cmp_lt_u32 s56, 60400
    s_cbranch_scc1 L_gp_40

L_gpd_41:
    s_mov_b32 s56, 0
L_gate_47:
    buffer_load_dwordx4 v[116:119], v13, s[28:31], s78 offen offset:0 sc1
    v_mov_b32 v16, 0
    s_waitcnt vmcnt(0)
    v_bitop3_b32 v16, v16, v116, s48 bitop3:0xf6
    v_bitop3_b32 v16, v16, v117, s49 bitop3:0xf6
    v_bitop3_b32 v16, v16, v118, s50 bitop3:0xf6
    v_bitop3_b32 v16, v16, v119, s51 bitop3:0xf6
    v_and_b32 v16, 0xff, v16
    v_cmp_eq_u32 vcc, 0, v16
    s_cbranch_vccnz L_gated_48
    s_add_u32 s56, s56, 1
    s_cmp_lt_u32 s56, 400
    s_cbranch_scc1 L_gate_47
    buffer_wbl2 sc1
    s_waitcnt vmcnt(0)
    buffer_inv sc1
    s_waitcnt vmcnt(0)
    s_cmp_lt_u32 s56, 60400
    s_cbranch_scc1 L_gate_47

L_gated_48:
    s_mov_b32 s56, 0
    s_mov_b32 s57, 31
L_gp_49:
    s_bitcmp1_b32 s57, 0
    s_cbranch_scc0 L_gs_52
    buffer_load_dwordx4 v[116:119], v13, s[28:31], s78 offen offset:0 sc1
L_gs_52:
    s_bitcmp1_b32 s57, 1
    s_cbranch_scc0 L_gs_53
    buffer_load_dwordx4 v[84:87], v11, s[28:31], s74 offen offset:0 sc1
L_gs_53:
    s_bitcmp1_b32 s57, 2
    s_cbranch_scc0 L_gs_54
    buffer_load_dwordx4 v[88:91], v11, s[28:31], s75 offen offset:0 sc1
L_gs_54:
    s_bitcmp1_b32 s57, 3
    s_cbranch_scc0 L_gs_55
    buffer_load_dwordx4 v[92:95], v11, s[28:31], s76 offen offset:0 sc1
L_gs_55:
    s_bitcmp1_b32 s57, 4
    s_cbranch_scc0 L_gs_56
    buffer_load_dwordx4 v[96:99], v11, s[28:31], s77 offen offset:0 sc1
L_gs_56:
L_gpc_51:
    s_waitcnt vmcnt(0)
    s_bitcmp1_b32 s57, 0
    s_cbranch_scc0 L_gc_57
    v_mov_b32 v16, 0
    v_bitop3_b32 v16, v16, v116, s48 bitop3:0xf6
    v_bitop3_b32 v16, v16, v117, s49 bitop3:0xf6
    v_bitop3_b32 v16, v16, v118, s50 bitop3:0xf6
    v_bitop3_b32 v16, v16, v119, s51 bitop3:0xf6
    v_and_b32 v16, 0xff, v16
    v_cmp_ne_u32 vcc, 0, v16
    s_cbranch_vccnz L_gc_57
    s_bitset0_b32 s57, 0
    v_and_b32 v116, 0xffffff00, v116
    v_and_b32 v117, 0xffffff00, v117
L_gc_57:
    s_bitcmp1_b32 s57, 1
    s_cbranch_scc0 L_gc_58
    v_cmp_eq_u32 vcc, -1, v87
    s_cbranch_vccnz L_gc_58
    s_bitset0_b32 s57, 1
    v_lshlrev_b32 v200, 16, v84
    v_and_b32 v201, 0xffff0000, v84
    v_lshlrev_b32 v202, 16, v85
    v_and_b32 v203, 0xffff0000, v85
    v_lshlrev_b32 v204, 16, v86
    v_and_b32 v205, 0xffff0000, v86
    v_lshlrev_b32 v206, 16, v87
    v_and_b32 v207, 0xffff0000, v87
L_gc_58:
    s_bitcmp1_b32 s57, 2
    s_cbranch_scc0 L_gc_59
    v_cmp_eq_u32 vcc, -1, v91
    s_cbranch_vccnz L_gc_59
    s_bitset0_b32 s57, 2
    v_lshlrev_b32 v208, 16, v88
    v_and_b32 v209, 0xffff0000, v88
    v_lshlrev_b32 v210, 16, v89
    v_and_b32 v211, 0xffff0000, v89
    v_lshlrev_b32 v212, 16, v90
    v_and_b32 v213, 0xffff0000, v90
    v_lshlrev_b32 v214, 16, v91
    v_and_b32 v215, 0xffff0000, v91
L_gc_59:
    s_bitcmp1_b32 s57, 3
    s_cbranch_scc0 L_gc_60
    v_cmp_eq_u32 vcc, -1, v95
    s_cbranch_vccnz L_gc_60
    s_bitset0_b32 s57, 3
    v_lshlrev_b32 v216, 16, v92
    v_and_b32 v217, 0xffff0000, v92
    v_lshlrev_b32 v218, 16, v93
    v_and_b32 v219, 0xffff0000, v93
    v_lshlrev_b32 v220, 16, v94
    v_and_b32 v221, 0xffff0000, v94
    v_lshlrev_b32 v222, 16, v95
    v_and_b32 v223, 0xffff0000, v95
L_gc_60:
    s_bitcmp1_b32 s57, 4
    s_cbranch_scc0 L_gc_61
    v_cmp_eq_u32 vcc, -1, v99
    s_cbranch_vccnz L_gc_61
    s_bitset0_b32 s57, 4
    v_lshlrev_b32 v224, 16, v96
    v_and_b32 v225, 0xffff0000, v96
    v_lshlrev_b32 v226, 16, v97
    v_and_b32 v227, 0xffff0000, v97
    v_lshlrev_b32 v228, 16, v98
    v_and_b32 v229, 0xffff0000, v98
    v_lshlrev_b32 v230, 16, v99
    v_and_b32 v231, 0xffff0000, v99
L_gc_61:
    s_cmp_eq_u32 s57, 0
    s_cbranch_scc1 L_gpd_50
    s_add_u32 s56, s56, 1
    s_cmp_lt_u32 s56, 400
    s_cbranch_scc1 L_gp_49
    buffer_wbl2 sc1
    s_waitcnt vmcnt(0)
    buffer_inv sc1
    s_waitcnt vmcnt(0)
    s_cmp_lt_u32 s56, 60400
    s_cbranch_scc1 L_gp_49

L_gpd_50:
    v_pk_add_f32 v[200:201], v[200:201], v[208:209]
    v_add_f32_dpp v116, v116, v116 row_ror:8 row_mask:0xf bank_mask:0xf
    v_pk_add_f32 v[202:203], v[202:203], v[210:211]
    v_add_f32_dpp v117, v117, v117 row_ror:8 row_mask:0xf bank_mask:0xf
    v_pk_add_f32 v[204:205], v[204:205], v[212:213]
    v_mov_b32 v118, v116
    v_pk_add_f32 v[206:207], v[206:207], v[214:215]
    v_mov_b32 v119, v117
    v_pk_add_f32 v[216:217], v[216:217], v[224:225]
    s_nop 0
    v_pk_add_f32 v[218:219], v[218:219], v[226:227]
    v_permlane16_swap_b32 v116, v118
    v_pk_add_f32 v[220:221], v[220:221], v[228:229]
    v_permlane16_swap_b32 v117, v119
    v_pk_add_f32 v[222:223], v[222:223], v[230:231]
    v_add_f32 v116, v116, v118
    v_pk_add_f32 v[84:85], v[200:201], v[216:217]
    v_add_f32 v117, v117, v119
    v_pk_add_f32 v[86:87], v[202:203], v[218:219]
    v_mov_b32 v118, v116
    v_pk_add_f32 v[88:89], v[204:205], v[220:221]
    v_mov_b32 v119, v117
    v_pk_add_f32 v[90:91], v[206:207], v[222:223]
    s_nop 0
    s_nop 0
    v_permlane32_swap_b32 v116, v118
    v_add_f32_dpp v84, v84, v84 row_ror:8 row_mask:0xf bank_mask:0xf
    v_permlane32_swap_b32 v117, v119
    v_add_f32_dpp v85, v85, v85 row_ror:8 row_mask:0xf bank_mask:0xf
    v_add_f32 v116, v116, v118
    v_add_f32_dpp v86, v86, v86 row_ror:8 row_mask:0xf bank_mask:0xf
    v_add_f32 v117, v117, v119
    v_add_f32_dpp v87, v87, v87 row_ror:8 row_mask:0xf bank_mask:0xf
    v_mul_f32 v128, 0x3a800000, v116
    v_add_f32_dpp v88, v88, v88 row_ror:8 row_mask:0xf bank_mask:0xf
    v_mul_f32 v131, 0x3a800000, v117
    v_add_f32_dpp v89, v89, v89 row_ror:8 row_mask:0xf bank_mask:0xf
    v_fma_f32 v131, -v128, v128, v131
    v_add_f32_dpp v90, v90, v90 row_ror:8 row_mask:0xf bank_mask:0xf
    v_max_f32 v131, 0, v131
    v_add_f32_dpp v91, v91, v91 row_ror:8 row_mask:0xf bank_mask:0xf
    v_cvt_pk_bf16_f32 v128, v128, v131
    v_and_b32 v131, 0xffff0000, v128
    v_lshlrev_b32 v128, 16, v128
    v_add_f32 v131, 0x3727c5ac, v131
    v_cvt_pk_bf16_f32 v131, v131, v131
    v_and_b32 v131, 0xffff0000, v131
    v_sqrt_f32 v130, v131
    s_nop 0
    v_cvt_pk_bf16_f32 v130, v130, v130
    v_and_b32 v130, 0xffff0000, v130
    v_rcp_f32 v129, v130
    s_nop 0
    v_fma_f32 v131, -v130, v129, 1.0
    v_fma_f32 v129, v131, v129, v129
    v_mul_f32 v128, v128, v129
    v_mul_f32 v120, v120, v128
    v_mul_f32 v121, v121, v128
    v_mul_f32 v122, v122, v128
    v_mul_f32 v123, v123, v128
    v_mul_f32 v124, v124, v128
    v_mul_f32 v125, v125, v128
    v_mul_f32 v126, v126, v128
    v_mul_f32 v127, v127, v128
    v_fma_f32 v84, v84, v129, -v120
    v_fma_f32 v85, v85, v129, -v121
    v_fma_f32 v86, v86, v129, -v122
    v_fma_f32 v87, v87, v129, -v123
    v_fma_f32 v88, v88, v129, -v124
    v_fma_f32 v89, v89, v129, -v125
    v_fma_f32 v90, v90, v129, -v126
    v_fma_f32 v91, v91, v129, -v127
    v_cvt_pk_bf16_f32 v92, v84, v85
    v_cvt_pk_bf16_f32 v93, v86, v87
    v_cvt_pk_bf16_f32 v94, v88, v89
    v_cvt_pk_bf16_f32 v95, v90, v91
    v_pk_max_i16 v92, v92, 0
    v_pk_max_i16 v93, v93, 0
    v_pk_max_i16 v94, v94, 0
    v_pk_max_i16 v95, v95, 0
    s_nop 1
    v_mfma_f32_16x16x32_bf16 v[200:203], v[52:55], v[92:95], 0
    v_mfma_f32_16x16x32_bf16 v[204:207], v[56:59], v[92:95], 0
    v_mfma_f32_16x16x32_bf16 v[208:211], v[60:63], v[92:95], 0
    v_mfma_f32_16x16x32_bf16 v[212:215], v[64:67], v[92:95], 0
    v_mfma_f32_16x16x32_bf16 v[216:219], v[68:71], v[92:95], 0
    v_mfma_f32_16x16x32_bf16 v[220:223], v[72:75], v[92:95], 0
    v_mfma_f32_16x16x32_bf16 v[224:227], v[76:79], v[92:95], 0
    v_mfma_f32_16x16x32_bf16 v[228:231], v[80:83], v[92:95], 0
    s_nop 0
    s_mov_b32 exec_lo, 0xff00ff
    s_mov_b32 exec_hi, 0xff00ff
    ds_write_b128 v7, v[200:203] offset:24704
    ds_write_b128 v7, v[204:207] offset:24768
    ds_write_b128 v7, v[208:211] offset:24832
    ds_write_b128 v7, v[212:215] offset:24896
    ds_write_b128 v7, v[216:219] offset:24960
    ds_write_b128 v7, v[220:223] offset:25024
    ds_write_b128 v7, v[224:227] offset:25088
    ds_write_b128 v7, v[228:231] offset:25152
    s_mov_b64 exec, -1
    s_waitcnt lgkmcnt(0)
    s_barrier
    ds_read_b128 v[200:203], v8 offset:24704
    ds_read_b128 v[204:207], v8 offset:29696
    ds_read_b128 v[208:211], v8 offset:34688
    ds_read_b128 v[212:215], v8 offset:39680
    s_waitcnt lgkmcnt(2)
    v_pk_add_f32 v[200:201], v[200:201], v[204:205]
    v_pk_add_f32 v[202:203], v[202:203], v[206:207]
    s_waitcnt lgkmcnt(0)
    v_pk_add_f32 v[208:209], v[208:209], v[212:213]
    v_pk_add_f32 v[210:211], v[210:211], v[214:215]
    v_pk_add_f32 v[200:201], v[200:201], v[208:209]
    v_pk_add_f32 v[202:203], v[202:203], v[210:211]
    v_add_u32 v200, 0x80, v200
    v_add_u32 v201, 0x80, v201
    v_add_u32 v202, 0x80, v202
    v_add_u32 v203, 0x80, v203
    v_bfi_b32 v200, v6, s96, v200
    v_bfi_b32 v201, v6, s97, v201
    v_bfi_b32 v202, v6, s98, v202
    v_bfi_b32 v203, v6, s99, v203
    buffer_store_dwordx4 v[200:203], v19, s[28:31], s71 offen offset:0
    s_cmp_eq_u32 s65, 0
    s_cbranch_scc1 L_nodual
    buffer_store_dwordx4 v[200:203], v19, s[44:47], s71 offen sc1
L_nodual:
L_final:
    s_mov_b32 s36, s20
    s_mov_b32 s37, s21
    s_mov_b32 s38, 0x4000
    s_mov_b32 s39, 0x20000
    v_mov_b32 v84, 0
    v_mov_b32 v85, 0
    v_mov_b32 v86, 0
    v_mov_b32 v87, 0
    s_cmp_lt_u32 s53, 28
    s_cbranch_scc1 L_ytight
    s_mov_b32 s56, 0
    s_mov_b32 s57, 0
L_poll_62:
    s_mov_b32 exec_lo, 0xfffffff
    s_mov_b32 exec_hi, 0xfffffff
    buffer_load_dwordx4 v[84:87], v157, s[32:35], s27 offen offset:0 sc1
    s_mov_b64 exec, -1
L_pollc_64:
    v_mov_b32 v16, 0
    s_waitcnt vmcnt(0)
    s_mov_b32 exec_lo, 0xfffffff
    s_mov_b32 exec_hi, 0xfffffff
    v_bitop3_b32 v16, v16, v84, s96 bitop3:0xf6
    v_bitop3_b32 v16, v16, v85, s97 bitop3:0xf6
    v_bitop3_b32 v16, v16, v86, s98 bitop3:0xf6
    v_bitop3_b32 v16, v16, v87, s99 bitop3:0xf6
    s_mov_b64 exec, -1
    v_and_b32 v16, 0xff, v16
    v_cmp_ne_u32 vcc, 0, v16
    s_cbranch_vccz L_polld_63
    s_add_u32 s56, s56, 1

    s_sleep 2
    s_cmp_lt_u32 s56, 400
    s_cbranch_scc1 L_poll_62
    buffer_wbl2 sc1
    s_waitcnt vmcnt(0)
    buffer_inv sc1
    s_waitcnt vmcnt(0)

    s_xor_b32 s57, s57, 0x1000000
    s_add_u32 s32, s24, s57
    s_addc_u32 s33, s25, 0
    s_cmp_lt_u32 s56, 60400
    s_cbranch_scc1 L_poll_62
L_polld_63:
    s_branch L_yin
L_ytight:
    s_mov_b32 s56, 0
    s_mov_b32 s57, 0
L_poll_65:
    s_mov_b32 exec_lo, 0xfffffff
    s_mov_b32 exec_hi, 0xfffffff
    buffer_load_dwordx4 v[84:87], v157, s[32:35], s27 offen offset:0 sc1
    s_mov_b64 exec, -1
L_pollc_67:
    v_mov_b32 v16, 0
    s_waitcnt vmcnt(0)
    s_mov_b32 exec_lo, 0xfffffff
    s_mov_b32 exec_hi, 0xfffffff
    v_bitop3_b32 v16, v16, v84, s96 bitop3:0xf6
    v_bitop3_b32 v16, v16, v85, s97 bitop3:0xf6
    v_bitop3_b32 v16, v16, v86, s98 bitop3:0xf6
    v_bitop3_b32 v16, v16, v87, s99 bitop3:0xf6
    s_mov_b64 exec, -1
    v_and_b32 v16, 0xff, v16
    v_cmp_ne_u32 vcc, 0, v16
    s_cbranch_vccz L_polld_66
    s_add_u32 s56, s56, 1

    s_cmp_lt_u32 s56, 400
    s_cbranch_scc1 L_poll_65
    buffer_wbl2 sc1
    s_waitcnt vmcnt(0)
    buffer_inv sc1
    s_waitcnt vmcnt(0)

    s_xor_b32 s57, s57, 0x1000000
    s_add_u32 s32, s24, s57
    s_addc_u32 s33, s25, 0
    s_cmp_lt_u32 s56, 60400
    s_cbranch_scc1 L_poll_65
L_polld_66:
L_yin:
    v_and_b32 v84, 0xffffff00, v84
    v_and_b32 v85, 0xffffff00, v85
    v_and_b32 v86, 0xffffff00, v86
    v_and_b32 v87, 0xffffff00, v87
    v_add_f32_dpp v84, v84, v84 quad_perm:[1,0,3,2] row_mask:0xf bank_mask:0xf
    v_add_f32_dpp v85, v85, v85 quad_perm:[1,0,3,2] row_mask:0xf bank_mask:0xf
    v_add_f32_dpp v86, v86, v86 quad_perm:[1,0,3,2] row_mask:0xf bank_mask:0xf
    v_add_f32_dpp v87, v87, v87 quad_perm:[1,0,3,2] row_mask:0xf bank_mask:0xf
    v_add_f32_dpp v84, v84, v84 quad_perm:[2,3,0,1] row_mask:0xf bank_mask:0xf
    v_add_f32_dpp v85, v85, v85 quad_perm:[2,3,0,1] row_mask:0xf bank_mask:0xf
    v_add_f32_dpp v86, v86, v86 quad_perm:[2,3,0,1] row_mask:0xf bank_mask:0xf
    v_add_f32_dpp v87, v87, v87 quad_perm:[2,3,0,1] row_mask:0xf bank_mask:0xf
    v_add_f32_dpp v84, v84, v84 row_half_mirror row_mask:0xf bank_mask:0xf
    v_add_f32_dpp v85, v85, v85 row_half_mirror row_mask:0xf bank_mask:0xf
    v_add_f32_dpp v86, v86, v86 row_half_mirror row_mask:0xf bank_mask:0xf
    v_add_f32_dpp v87, v87, v87 row_half_mirror row_mask:0xf bank_mask:0xf
    v_add_f32_dpp v84, v84, v84 row_mirror row_mask:0xf bank_mask:0xf
    v_add_f32_dpp v85, v85, v85 row_mirror row_mask:0xf bank_mask:0xf
    v_add_f32_dpp v86, v86, v86 row_mirror row_mask:0xf bank_mask:0xf
    v_add_f32_dpp v87, v87, v87 row_mirror row_mask:0xf bank_mask:0xf
    v_mov_b32 v88, v84
    v_mov_b32 v89, v85
    v_mov_b32 v90, v86
    v_mov_b32 v91, v87
    v_permlane16_swap_b32 v84, v88
    v_permlane16_swap_b32 v85, v89
    v_permlane16_swap_b32 v86, v90
    v_permlane16_swap_b32 v87, v91
    v_add_f32 v84, v84, v88
    v_add_f32 v85, v85, v89
    v_add_f32 v86, v86, v90
    v_add_f32 v87, v87, v91
    v_cvt_pk_bf16_f32 v88, v84, v85
    v_cvt_pk_bf16_f32 v89, v86, v87
    v_and_b32 v152, 0xffff0000, v152
    v_and_b32 v153, 0xffff0000, v153
    v_and_b32 v154, 0xffff0000, v154
    v_and_b32 v155, 0xffff0000, v155
    v_lshlrev_b32 v84, 16, v88
    v_and_b32 v85, 0xffff0000, v88
    v_lshlrev_b32 v86, 16, v89
    v_and_b32 v87, 0xffff0000, v89
    v_pk_add_f32 v[84:85], v[84:85], v[152:153]
    v_pk_add_f32 v[86:87], v[86:87], v[154:155]
    v_cvt_pk_bf16_f32 v88, v84, v85
    v_cvt_pk_bf16_f32 v89, v86, v87
    s_mov_b32 exec_lo, 0x1
    s_mov_b32 exec_hi, 0x1
    buffer_store_short v88, v158, s[36:39], s79 offen
    buffer_store_short_d16_hi v88, v158, s[36:39], s79 offen offset:16
    buffer_store_short v89, v158, s[36:39], s79 offen offset:32
    buffer_store_short_d16_hi v89, v158, s[36:39], s79 offen offset:48
    s_or_b32 s60, s2, s3
    s_cmp_lg_u32 s60, 0
    s_cbranch_scc1 L_noepoch
    s_mov_b64 exec, 1
    v_mov_b32 v84, s96
    buffer_store_dword v84, v4, s[28:31], 0 offen
L_noepoch:
    s_mov_b64 exec, -1
L_end:
    s_endpgm
.section .rodata,"a"
.p2align 6
.amdhsa_kernel sequential_preLN__sliding_block_cached__dense_activation_relu__decode_kernel
  .amdhsa_next_free_vgpr 236
  .amdhsa_next_free_sgpr 100
  .amdhsa_accum_offset 236
  .amdhsa_group_segment_fixed_size 0
  .amdhsa_kernarg_size 88
  .amdhsa_user_sgpr_count 2
  .amdhsa_user_sgpr_kernarg_segment_ptr 1
  .amdhsa_system_sgpr_workgroup_id_x 1
  .amdhsa_float_denorm_mode_32 3
.end_amdhsa_kernel
```
